```python
import torch

def _softmax(x, axis=-1):
    return torch.softmax(x, dim=axis)
def _gelu(x):
    return torch.nn.functional.gelu(x, approximate="tanh")
def _silu(x):
    return torch.nn.functional.silu(x)
def _sigmoid(x):
    return torch.sigmoid(x)
def _layernorm(x, axis=-1, eps=1e-5):
    m = x.mean(dim=axis, keepdim=True)
    v = x.var(dim=axis, keepdim=True, unbiased=False)
    return (x - m) / torch.sqrt(v + eps)
def _scatter_add(tgt, idx, src, axis=0):
    return tgt.clone().index_add_(axis, idx, src)
def _segment_sum(src, seg, n):
    out = torch.zeros((n,) + src.shape[1:], dtype=src.dtype)
    return out.index_add_(0, seg, src)
def _pad(x, pw):
    flat = tuple(v for pair in reversed(pw) for v in pair)
    return torch.nn.functional.pad(x, flat)

kernel_name = 'concat_heads__gqa_block_cached__gqa_block_cached__near_ridge'

def setup_inputs():

    _w = (lambda a: (lambda t: t.to(torch.bfloat16) if t.is_floating_point() else t)(torch.as_tensor(a)))
    def _A_setup():
        B, Sq, D = 8, 64, 512
        Hq, Hkv, Sk, Dh = 32, 8, 2048, 128
        assert Hq % Hkv == 0, (Hq, Hkv)
        return {
            "x": _w((lambda *s: torch.randn(*s, dtype=torch.bfloat16) * 0.8)(B, Sq, D)),
            "k_cache": _w((lambda *s: torch.randn(*s, dtype=torch.bfloat16) * 0.8)(B, Hkv, Sk, Dh)),
            "v_cache": _w((lambda *s: torch.randn(*s, dtype=torch.bfloat16) * 0.05)(B, Hkv, Sk, Dh)),
            "wq": _w((lambda *s: torch.randn(*s, dtype=torch.bfloat16) * 0.8)(D, Hq * Dh) * (D ** -0.5)),
            "wo": _w((lambda *s: torch.randn(*s, dtype=torch.bfloat16) * 0.05)(Hq * Dh, D) * ((Hq * Dh) ** -0.5)),
        }
    _A_in = _A_setup()

    def _B_setup():
        B, Sq, D = 8, 64, 512
        Hq, Hkv, Sk, Dh = 32, 8, 2048, 128
        assert Hq % Hkv == 0, (Hq, Hkv)
        return {
            "x": _w((lambda *s: torch.randn(*s, dtype=torch.bfloat16) * 0.8)(B, Sq, D)),
            "k_cache": _w((lambda *s: torch.randn(*s, dtype=torch.bfloat16) * 0.8)(B, Hkv, Sk, Dh)),
            "v_cache": _w((lambda *s: torch.randn(*s, dtype=torch.bfloat16) * 0.05)(B, Hkv, Sk, Dh)),
            "wq": _w((lambda *s: torch.randn(*s, dtype=torch.bfloat16) * 0.8)(D, Hq * Dh) * (D ** -0.5)),
            "wo": _w((lambda *s: torch.randn(*s, dtype=torch.bfloat16) * 0.05)(Hq * Dh, D) * ((Hq * Dh) ** -0.5)),
        }
    _B_in = _B_setup()

    return {
        "A_x": _A_in["x"],
        "A_k_cache": _A_in["k_cache"],
        "A_v_cache": _A_in["v_cache"],
        "A_wq": _A_in["wq"],
        "A_wo": _A_in["wo"],
        "B_x": _B_in["x"],
        "B_k_cache": _B_in["k_cache"],
        "B_v_cache": _B_in["v_cache"],
        "B_wq": _B_in["wq"],
        "B_wo": _B_in["wo"],
    }

def reference(A_x, A_k_cache, A_v_cache, A_wq, A_wo, B_x, B_k_cache, B_v_cache, B_wq, B_wo):
    def _A_ref(x, k_cache, v_cache, wq, wo):
        B, Sq, D = x.shape
        Hq, Dh = 32, 128
        Hkv = k_cache.shape[1]
        rep = Hq // Hkv
        q = (lambda x, *d: x.permute(*d))((x @ wq).reshape(B, Sq, Hq, Dh), 0, 2, 1, 3)
        k = (lambda x, n, axis: torch.repeat_interleave(x, n, dim=axis))(k_cache, rep, axis=1)
        v = (lambda x, n, axis: torch.repeat_interleave(x, n, dim=axis))(v_cache, rep, axis=1)
        scores = torch.einsum("bhqd,bhkd->bhqk", q, k) * (Dh ** -0.5)
        p = _softmax(scores, axis=-1)
        o = torch.einsum("bhqk,bhkd->bhqd", p, v)
        return (lambda x, *d: x.permute(*d))(o, 0, 2, 1, 3).reshape(B, Sq, Hq * Dh) @ wo

    def _B_ref(x, k_cache, v_cache, wq, wo):
        B, Sq, D = x.shape
        Hq, Dh = 32, 128
        Hkv = k_cache.shape[1]
        rep = Hq // Hkv
        q = (lambda x, *d: x.permute(*d))((x @ wq).reshape(B, Sq, Hq, Dh), 0, 2, 1, 3)
        k = (lambda x, n, axis: torch.repeat_interleave(x, n, dim=axis))(k_cache, rep, axis=1)
        v = (lambda x, n, axis: torch.repeat_interleave(x, n, dim=axis))(v_cache, rep, axis=1)
        scores = torch.einsum("bhqd,bhkd->bhqk", q, k) * (Dh ** -0.5)
        p = _softmax(scores, axis=-1)
        o = torch.einsum("bhqk,bhkd->bhqd", p, v)
        return (lambda x, *d: x.permute(*d))(o, 0, 2, 1, 3).reshape(B, Sq, Hq * Dh) @ wo

    a = _A_ref(A_x, A_k_cache, A_v_cache, A_wq, A_wo)
    b = _B_ref(B_x, B_k_cache, B_v_cache, B_wq, B_wo)
    return torch.concatenate([a, b], axis=-1)
```

```asm
; @launch grid=(256,1,1) block=(256,1,1) lds=163840
.amdgcn_target "amdgcn-amd-amdhsa--gfx950"
.text
.globl concat_heads__gqa_block_cached__gqa_block_cached__near_ridge_kernel
.p2align 8
.type concat_heads__gqa_block_cached__gqa_block_cached__near_ridge_kernel,@function
concat_heads__gqa_block_cached__gqa_block_cached__near_ridge_kernel:
  s_cmp_ge_u32 s2, 256
  s_cbranch_scc1 L_end
  s_mov_b32 s101, 0
L_top:
  s_bfe_u32 s39, s2, 0x10002
  s_mul_i32 s45, s39, 40
  s_add_u32 s62, s0, s45
  s_addc_u32 s63, s1, 0
  s_load_dwordx8 s[48:55], s[62:63], 0
  s_load_dwordx2 s[56:57], s[62:63], 32
  s_load_dwordx4 s[64:67], s[0:1], 80
  s_load_dwordx2 s[24:25], s[0:1], 96
  s_getpc_b64 s[88:89]
L_pf:
  s_mov_b32 s90, L_last-L_pf
  s_mov_b32 s91, 0x20000
  s_lshr_b32 s62, s2, 3
  s_mul_i32 s62, s62, 1280
  v_cmp_gt_u32 vcc, 10, v0
  v_lshl_add_u32 v2, v0, 7, s62
  s_nop 0
  v_cndmask_b32 v31, 2.0, v2, vcc
  buffer_load_dword v75, v31, s[88:91], 0 offen
  v_readfirstlane_b32 s40, v0
  v_and_b32 v23, 15, v0
  v_bfe_u32 v24, v0, 4, 2
  s_lshr_b32 s38, s2, 5
  s_bfe_u32 s46, s2, 0x20003
  s_lshl_b32 s41, s40, 6
  s_lshr_b32 s40, s40, 6
  v_xor_b32 v3, v24, v23
  v_lshlrev_b32_e64 v16, 4, v3
  v_lshl_add_u32 v104, v24, 10, v16
  v_lshlrev_b32 v3, 1, v24
  v_xor_b32 v3, v3, v23
  v_lshlrev_b32_e64 v20, 4, v3
  v_lshl_add_u32 v112, v24, 13, v20
  v_xor_b32_e64 v3, 64, v104
  v_add_u32 v105, 3072, v3
  v_xor_b32 v3, 128, v104
  v_add_u32 v106, 6144, v3
  v_xor_b32 v3, 192, v104
  v_add_u32 v107, 9216, v3
  v_xor_b32 v3, 0x80, v112
  v_add_u32 v113, 64512, v3
  v_add_u32 v114, 129024, v112
  v_add_u32 v115, 193536, v3
  s_and_b32 s42, s46, 2
  s_add_u32 s42, s42, s38
  s_lshl_b32 s42, s42, 1
  s_and_b32 s61, s2, 3
  s_lshl2_add_u32 s61, s61, s46
  s_and_b32 s58, s40, 1
  s_lshr_b32 s59, s40, 1
  s_lshl2_add_u32 s45, s38, s40
  s_lshl_b32 s45, s45, 14
  s_lshl3_add_u32 s47, s59, s58
  s_lshl_b32 s47, s47, 6
  s_add_u32 s47, s47, s61
  s_lshl_b32 s46, s47, 9
  s_lshl_b32 s63, s42, 19
  s_and_b32 s63, s63, 0x3fffff
  s_mov_b32 s6, 16384
  s_mov_b32 s7, 0x20000
  s_sub_u32 s18, 4194304, s46
  s_mov_b32 s19, 0x20000
  s_waitcnt lgkmcnt(0)
  s_load_dword s94, s[54:55], s63
  s_add_u32 s4, s48, s45
  s_addc_u32 s5, s49, 0
  s_add_u32 s16, s54, s46
  s_addc_u32 s17, s55, 0
  s_add_u32 s47, s42, 0
  s_and_b32 s47, s47, 7
  s_lshl_b32 s47, s47, 7
  s_add_u32 m0, s41, 0
  s_nop 0
  buffer_load_dwordx4 v104, s[4:7], s47 offen offset:0  lds
  buffer_load_dwordx4 v105, s[4:7], s47 offen offset:1024  lds
  buffer_load_dwordx4 v106, s[4:7], s47 offen offset:2048  lds
  buffer_load_dwordx4 v107, s[4:7], s47 offen offset:3072  lds
  s_add_u32 s63, s42, 0
  s_and_b32 s63, s63, 7
  s_lshl_b32 s63, s63, 19
  s_add_u32 m0, s41, 65536
  s_nop 0
  buffer_load_dwordx4 v112, s[16:19], s63 offen offset:0  lds
  s_xor_b32 s63, s63, 0x100
  s_add_u32 m0, s41, 114688
  s_nop 0
  buffer_load_dwordx4 v112, s[16:19], s63 offen offset:0  lds
  s_xor_b32 s63, s63, 0x100
  s_add_u32 m0, s41, 65536
  s_nop 0
  buffer_load_dwordx4 v113, s[16:19], s63 offen offset:1024  lds
  s_xor_b32 s63, s63, 0x100
  s_add_u32 m0, s41, 114688
  s_nop 0
  buffer_load_dwordx4 v113, s[16:19], s63 offen offset:1024  lds
  s_xor_b32 s63, s63, 0x100
  s_add_u32 m0, s41, 65536
  s_nop 0
  buffer_load_dwordx4 v114, s[16:19], s63 offen offset:2048  lds
  s_xor_b32 s63, s63, 0x100
  s_add_u32 m0, s41, 114688
  s_nop 0
  buffer_load_dwordx4 v114, s[16:19], s63 offen offset:2048  lds
  s_xor_b32 s63, s63, 0x100
  s_add_u32 m0, s41, 65536
  s_nop 0
  buffer_load_dwordx4 v115, s[16:19], s63 offen offset:3072  lds
  s_xor_b32 s63, s63, 0x100
  s_add_u32 m0, s41, 114688
  s_nop 0
  buffer_load_dwordx4 v115, s[16:19], s63 offen offset:3072  lds
  s_lshr_b32 s36, s61, 1
  s_lshl3_add_u32 s60, s39, s38
  v_and_b32 v27, 63, v0
  v_lshlrev_b32_e64 v22, 4, v27
  s_add_u32 s24, s24, 0x1fffff
  s_addc_u32 s25, s25, 0
  s_and_b32 s24, s24, 0xffe00000
  s_mov_b32 s26, 266338304
  s_mov_b32 s27, 0x20000
  s_lshl_b32 s45, s38, 3
  s_add_u32 s45, s45, s36
  s_lshl_b32 s45, s45, 19
  s_add_u32 s8, s50, s45
  s_addc_u32 s9, s51, 0
  s_mov_b32 s10, 524288
  s_mov_b32 s11, 0x20000
  s_add_u32 s12, s52, s45
  s_addc_u32 s13, s53, 0
  s_mov_b32 s14, 524288
  s_mov_b32 s15, 0x20000
  s_lshl_b32 s45, s61, 18
  s_add_u32 s20, s56, s45
  s_addc_u32 s21, s57, 0
  s_mov_b32 s22, 262144
  s_mov_b32 s23, 0x20000
  s_mov_b32 s28, s64
  s_mov_b32 s29, s65
  s_mov_b32 s30, 1048576
  s_mov_b32 s31, 0x20000
  s_mov_b32 s32, s66
  s_mov_b32 s33, s67
  s_mov_b32 s34, 256
  s_mov_b32 s35, 0x20000
  s_cmp_eq_u32 s40, 1
  s_cbranch_scc0 L_t1
  s_load_dword s94, s[8:9], 0
  s_load_dword s95, s[12:13], 0
L_t1:
  s_cmp_eq_u32 s40, 2
  s_cbranch_scc0 L_t2
  s_lshl_b32 s45, s42, 19
  s_andn2_b32 s45, 0x200000, s45
  s_load_dword s94, s[16:17], s45
  s_load_dword s95, s[20:21], 0
L_t2:
  s_lshr_b32 s45, s2, 3
  s_lshl2_add_u32 s45, s45, s40
  s_cmp_eq_u32 s45, 3
  s_cbranch_scc0 L_t3
  s_load_dword s94, s[28:29], 0 glc
  s_load_dword s95, s[32:33], 0 glc
L_t3:
  s_mul_i32 s43, s36, 8
  s_mul_i32 s45, s38, 3
  s_add_u32 s43, s43, s45
  s_mul_i32 s45, s39, 16
  s_add_u32 s43, s43, s45
  s_mov_b32 s57, 0x67000
  s_lshl_b32 s44, s43, 12
  s_and_b32 s44, s44, 0x7000
  s_lshl_b32 s45, s43, 14
  s_and_b32 s45, s45, 0x60000
  s_or_b32 s44, s44, s45
  s_mov_b32 s43, s44
  s_add_u32 s45, s38, 0
  s_and_b32 s45, s45, 3
  s_lshl_b32 s52, s45, 8
  s_add_u32 s45, s38, 1
  s_and_b32 s45, s45, 3
  s_lshl_b32 s53, s45, 8
  s_add_u32 s45, s38, 2
  s_and_b32 s45, s45, 3
  s_lshl_b32 s54, s45, 8
  s_add_u32 s45, s38, 3
  s_and_b32 s45, s45, 3
  s_lshl_b32 s55, s45, 8
  s_mul_i32 s45, s58, 32768
  s_mul_i32 s46, s59, 65536
  s_xor_b32 s45, s45, s46
  s_lshl_b32 s46, s40, 14
  v_lshl_add_u32 v3, v24, 10, s46
  v_add_u32 v80, v3, v20
  v_xor_b32 v3, 0x80, v80
  v_add_u32 v81, 3072, v3
  v_add_u32 v82, 6144, v80
  v_add_u32 v83, 9216, v3
  v_mul_u32_u24 v3, 256, v24
  v_xor_b32 v3, s45, v3
  v_add_u32 v16, v16, v3
  v_add_u32 v20, v20, v3
  v_xor_b32 v17, 64, v16
  v_xor_b32 v18, 128, v16
  v_xor_b32 v19, 192, v16
  v_xor_b32 v21, 128, v20
  v_xor_b32 v3, v24, v23
  v_lshlrev_b32 v25, 8, v23
  v_xor_b32_e64 v26, 0, v3
  v_lshl_add_u32 v4, v26, 4, v25
  v_xor_b32_e64 v26, 4, v3
  v_lshl_add_u32 v5, v26, 4, v25
  v_xor_b32_e64 v26, 8, v3
  v_lshl_add_u32 v6, v26, 4, v25
  v_xor_b32_e64 v26, 12, v3
  v_lshl_add_u32 v7, v26, 4, v25
  v_lshrrev_b32_e64 v3, 2, v23
  v_lshl_add_u32 v3, v24, 2, v3
  v_and_b32 v25, 7, v3
  v_lshlrev_b32 v3, 8, v3
  v_and_b32_e64 v26, 3, v23
  v_lshl_add_u32 v3, v26, 3, v3
  v_add_u32 v3, 65536, v3
  v_xor_b32_e64 v26, 0, v25
  v_lshl_add_u32 v8, v26, 5, v3
  v_xor_b32_e64 v26, 1, v25
  v_lshl_add_u32 v9, v26, 5, v3
  v_xor_b32_e64 v26, 2, v25
  v_lshl_add_u32 v10, v26, 5, v3
  v_xor_b32_e64 v26, 3, v25
  v_lshl_add_u32 v11, v26, 5, v3
  v_xor_b32_e64 v26, 4, v25
  v_lshl_add_u32 v12, v26, 5, v3
  v_xor_b32_e64 v26, 5, v25
  v_lshl_add_u32 v13, v26, 5, v3
  v_xor_b32_e64 v26, 6, v25
  v_lshl_add_u32 v14, v26, 5, v3
  v_xor_b32_e64 v26, 7, v25
  v_lshl_add_u32 v15, v26, 5, v3
  s_and_b32 s46, s60, 1
  s_lshl1_add_u32 s45, s60, s46
  s_lshl_b32 s45, s45, 13
  s_add_u32 s45, s45, 33554432
  s_lshl_b32 s46, s61, 9
  s_add_u32 s46, s46, s45
  s_max_u32 s62, s40, 3
  s_lshl_b32 s62, s62, 7
  s_add_u32 s92, s62, s46
  s_cmp_eq_u32 s101, 0
  s_cbranch_scc0 L_old
  s_xor_b32 s37, s92, 0x2000
  s_load_dword s93, s[24:25], s92 glc
  s_load_dword s3, s[24:25], s37 glc
  s_cmp_eq_u32 s40, 0
  s_cbranch_scc0 L_old
  s_lshl_b32 s66, s60, 21
  s_mul_i32 s67, s61, 0x8100
  s_add_u32 s66, s66, s67
  s_xor_b32 s67, s66, 0x2000
  s_load_dword s94, s[24:25], s66 glc
  s_load_dword s65, s[24:25], s67 glc
L_old:
  s_lshl_b32 s62, s40, 9
  s_add_u32 s62, s62, s45
  v_cmp_gt_u32 vcc, 4, v27
  v_lshl_add_u32 v3, v27, 11, s62
  s_nop 0
  v_cndmask_b32 v28, 2.0, v3, vcc
  s_lshl_b32 s62, s40, 0
  s_xor_b32 s62, s62, s61
  v_lshlrev_b32 v3, 2, v27
  v_xor_b32_e64 v3, s62, v3
  v_lshlrev_b32 v29, v3, 1
  s_mul_i32 s46, s59, 49152
  s_lshl_b32 s45, s58, 7
  v_xor_b32 v120, s45, v8
  v_add_u32 v120, s46, v120
  v_xor_b32 v121, s45, v9
  v_add_u32 v121, s46, v121
  v_xor_b32 v122, s45, v10
  v_add_u32 v122, s46, v122
  v_xor_b32 v123, s45, v11
  v_add_u32 v123, s46, v123
  s_lshl_b32 s45, s58, 13
  v_mov_b32 v90, v4
  v_add_u32 v4, s45, v4
  v_mov_b32 v91, v5
  v_add_u32 v5, s45, v5
  v_mov_b32 v92, v6
  v_add_u32 v6, s45, v6
  v_mov_b32 v93, v7
  v_add_u32 v7, s45, v7
  s_lshl_b32 s62, s40, 6
  v_xor_b32 v118, s62, v8
  v_subrev_u32 v116, 65536, v118
  v_add_u32 v124, 65536, v118
  v_xor_b32_e64 v119, s62, v9
  v_subrev_u32 v117, 65536, v119
  v_add_u32 v125, 65536, v119
  v_add_u32 v8, s45, v8
  v_add_u32 v9, s45, v9
  v_add_u32 v10, s45, v10
  v_add_u32 v11, s45, v11
  v_add_u32 v12, s45, v12
  v_add_u32 v13, s45, v13
  v_add_u32_e64 v14, s45, v14
  v_add_u32 v15, s45, v15
  s_lshl_b32 s46, s59, 14
  s_add_u32 s46, s46, 131072
  s_add_u32 s62, s46, s45
  v_add_u32 v96, s62, v22
  v_xor_b32 v97, 0x2000, v96
  s_lshl_b32 s45, s58, 11
  s_add_u32 s46, s46, s45
  v_lshrrev_b32_e64 v3, 1, v24
  v_lshl_add_u32 v3, v3, 8, s46
  v_lshl_add_u32 v3, v23, 4, v3
  v_and_b32_e64 v25, 1, v24
  v_lshl_add_u32 v98, v25, 3, v3
  v_add_u32 v94, 49152, v22
  v_add_u32 v95, 81920, v22
  s_mul_i32 s45, s59, 32768
  s_lshl_b32 s46, s58, 11
  s_add_u32 s45, s45, s46
  v_add_u32_e64 v100, s45, v94
  v_xor_b32 v101, 0x800, v100
  s_lshl_b32 s45, s40, 10
  s_add_u32 s45, s45, 65536
  v_add_u32 v102, s45, v22
  v_xor_b32 v103, 0x400, v102
  v_add_u32 v73, 65536, v22
  v_lshl_add_u32 v72, s40, 2, v73
  s_lshl_b32 s51, s60, 21
  s_lshl4_add_u32 s45, s40, s61
  s_lshl_b32 s45, s45, 15
  s_add_u32 s50, s51, s45
  s_lshl_b32 s46, s40, 15
  s_add_u32 s51, s51, s46
  s_lshl_b32 s46, s40, 0
  s_xor_b32 s46, s46, s61
  s_and_b32 s45, s46, 8
  s_add_u32 s46, s46, s45
  s_lshl_b32 s46, s46, 10
  s_add_u32 s51, s51, s46
  s_lshl_b32 s62, s38, 17
  s_and_b32 s45, s61, 3
  s_lshl_b32 s45, s45, 6
  s_add_u32 s62, s62, s45
  s_lshl_b32 s45, s39, 10
  s_add_u32 s62, s62, s45
  s_add_u32 s45, s40, s38
  s_and_b32 s45, s45, 3
  s_lshl_b32 s45, s45, 8
  s_add_u32 s62, s62, s45
  s_lshr_b32 s45, s61, 2
  s_lshl_b32 s45, s45, 15
  s_add_u32 s62, s62, s45
  v_lshl_add_u32 v3, v23, 11, s62
  v_lshl_add_u32 v79, v24, 4, v3
  s_lshl_b32 s46, s60, 4
  v_cmp_eq_u32 vcc, 0, v0
  v_mov_b32 v27, s46
  s_nop 0
  v_cndmask_b32 v26, 2.0, v27, vcc
  v_add_u32_e64 v30, s50, v22
  s_lshl_b32 s64, s60, 4
  s_add_u32 s63, s42, 1
  s_and_b32 s63, s63, 7
  s_lshl_b32 s63, s63, 19
  s_add_u32 m0, s41, 81920
  s_nop 0
  buffer_load_dwordx4 v112, s[16:19], s63 offen offset:0  lds
  s_xor_b32 s63, s63, 0x100
  s_add_u32 m0, s41, 131072
  s_nop 0
  buffer_load_dwordx4 v112, s[16:19], s63 offen offset:0  lds
  s_xor_b32 s63, s63, 0x100
  s_add_u32 m0, s41, 81920
  s_nop 0
  buffer_load_dwordx4 v113, s[16:19], s63 offen offset:1024  lds
  s_xor_b32 s63, s63, 0x100
  s_add_u32 m0, s41, 131072
  s_nop 0
  buffer_load_dwordx4 v113, s[16:19], s63 offen offset:1024  lds
  s_xor_b32 s63, s63, 0x100
  s_add_u32 m0, s41, 81920
  s_nop 0
  buffer_load_dwordx4 v114, s[16:19], s63 offen offset:2048  lds
  s_xor_b32 s63, s63, 0x100
  s_add_u32 m0, s41, 131072
  s_nop 0
  buffer_load_dwordx4 v114, s[16:19], s63 offen offset:2048  lds
  s_xor_b32 s63, s63, 0x100
  s_add_u32 m0, s41, 81920
  s_nop 0
  buffer_load_dwordx4 v115, s[16:19], s63 offen offset:3072  lds
  s_xor_b32 s63, s63, 0x100
  s_add_u32 m0, s41, 131072
  s_nop 0
  buffer_load_dwordx4 v115, s[16:19], s63 offen offset:3072  lds
  s_add_u32 s47, s42, 2
  s_and_b32 s47, s47, 7
  s_lshl_b32 s47, s47, 7
  s_add_u32 m0, s41, 16384
  s_nop 0
  buffer_load_dwordx4 v104, s[4:7], s47 offen offset:0  lds
  buffer_load_dwordx4 v105, s[4:7], s47 offen offset:1024  lds
  buffer_load_dwordx4 v106, s[4:7], s47 offen offset:2048  lds
  buffer_load_dwordx4 v107, s[4:7], s47 offen offset:3072  lds
  s_mov_b64 exec, 0
  s_cmp_eq_u32 s40, 1
  s_cbranch_scc1 L_w1
  s_cmp_eq_u32 s40, 2
  s_cbranch_scc1 L_w2
  s_cmp_eq_u32 s40, 3
  s_cbranch_scc1 L_w3
  s_branch L_w0
  .p2align 12
L_wdone:
  s_mov_b64 exec, -1
  s_or_b32 s45, s101, s40
  s_cbranch_scc1 L_norace
  s_waitcnt lgkmcnt(0)
  s_not_b32 s95, s65
  s_load_dword s94, s[24:25], s66 glc
  s_load_dword s95, s[24:25], s67 glc
  s_waitcnt lgkmcnt(1)
L_norace:
  v_lshrrev_b32 v2, 2, v23
  v_cmp_eq_u32 vcc, v2, v24
  v_and_b32 v2, 1, v23
  v_lshlrev_b32 v2, 4, v2
  v_mov_b32 v3, 0x3f80
  v_lshlrev_b32 v2, v2, v3
  s_cmp_lg_u32 s95, s65
  s_cselect_b32 s45, 1, 0x10001
  v_mov_b32 v76, s45
  v_cndmask_b32 v2, 0, v2, vcc
  v_and_b32 v3, 2, v23
  v_cmp_eq_u32 vcc, 0, v3
  v_mov_b32 v84, 0
  v_mov_b32 v85, 0
  v_mov_b32 v88, 0
  v_mov_b32 v89, 0
  v_cndmask_b32 v86, 0, v2, vcc
  v_sub_u32 v87, v2, v86
  v_mov_b32 v3, 0x3f803f80
  v_xor_b32 v25, v23, v24
  v_and_b32 v25, 2, v25
  v_cmp_eq_u32 vcc, 0, v25
  s_nop 1
  v_cndmask_b32 v3, 0, v3, vcc
  v_and_b32 v25, 1, v23
  v_mul_u32_u24 v25, 0xaaaa, v25
  v_add_u32 v78, 0x4444, v25
  v_mov_b32_e64 v77, v3
  s_mov_b32 s68, 0x3e0293ee
  s_mov_b32 s69, 0x3e0293ee
  v_and_b32 v3, 3, v23
  v_xor_b32 v25, v3, v24
  v_lshlrev_b32_e64 v3, 8, v3
  v_lshl_add_u32 v99, v25, 4, v3
  s_waitcnt vmcnt(12) lgkmcnt(0)
  s_barrier
  ds_read_b64_tr_b16 a[160:161], v120 offset:0
  ds_read_b64_tr_b16 a[162:163], v120 offset:4096
  s_add_u32 s63, s42, 2
  ds_read_b128 a[96:99], v90 offset:0
  s_and_b32 s63, s63, 7
  ds_read_b64_tr_b16 a[164:165], v121 offset:0
  s_lshl_b32 s63, s63, 19
  ds_read_b64_tr_b16 a[166:167], v121 offset:4096
  s_add_u32 m0, s41, 98304
  ds_read_b64_tr_b16 a[168:169], v122 offset:0
  buffer_load_dwordx4 v112, s[16:19], s63 offen offset:0  lds
  ds_read_b64_tr_b16 a[170:171], v122 offset:4096
  ds_read_b64_tr_b16 a[172:173], v123 offset:0
  ds_read_b64_tr_b16 a[174:175], v123 offset:4096
  buffer_load_dwordx4 v113, s[16:19], s63 offen offset:1024  lds
  ds_read_b128 a[100:103], v90 offset:4096
  ds_read_b128 a[104:107], v90 offset:8192
  ds_read_b128 a[108:111], v90 offset:12288
  buffer_load_dwordx4 v114, s[16:19], s63 offen offset:2048  lds
  ds_read_b64_tr_b16 a[176:177], v120 offset:8192
  ds_read_b64_tr_b16 a[178:179], v120 offset:12288
  buffer_load_dwordx4 v115, s[16:19], s63 offen offset:3072  lds
  s_add_u32 s63, s63, 256
  ds_read_b128 a[124:127], v91 offset:12288
  ds_read_b64_tr_b16 a[180:181], v121 offset:8192
  s_add_u32 m0, s41, 147456
  ds_read_b64_tr_b16 a[182:183], v121 offset:12288
  buffer_load_dwordx4 v112, s[16:19], s63 offen offset:0  lds
  s_waitcnt lgkmcnt(14)
  v_mfma_f32_16x16x32_bf16 v[128:131], a[160:163], a[96:99], 0
  s_waitcnt lgkmcnt(12)
  ds_read_b64_tr_b16 a[184:185], v122 offset:8192
  v_mfma_f32_16x16x32_bf16 v[132:135], a[164:167], a[96:99], 0
  s_waitcnt lgkmcnt(11)
  ds_read_b64_tr_b16 a[186:187], v122 offset:12288
  v_mfma_f32_16x16x32_bf16 v[136:139], a[168:171], a[96:99], 0
  s_waitcnt lgkmcnt(10)
  buffer_load_dwordx4 v113, s[16:19], s63 offen offset:1024  lds
  ds_read_b64_tr_b16 a[188:189], v123 offset:8192
  v_mfma_f32_16x16x32_bf16 v[140:143], a[172:175], a[96:99], 0
  s_waitcnt lgkmcnt(10)
  ds_read_b64_tr_b16 a[190:191], v123 offset:12288
  v_mfma_f32_16x16x32_bf16 v[156:159], a[172:175], a[100:103], 0
  ds_read_b128 a[120:123], v91 offset:8192
  v_mfma_f32_16x16x32_bf16 v[152:155], a[168:171], a[100:103], 0
  buffer_load_dwordx4 v114, s[16:19], s63 offen offset:2048  lds
  v_mfma_f32_16x16x32_bf16 v[148:151], a[164:167], a[100:103], 0
  ds_read_b128 a[116:119], v91 offset:4096
  v_mfma_f32_16x16x32_bf16 v[144:147], a[160:163], a[100:103], 0
  s_waitcnt lgkmcnt(12)
  ds_read_b128 a[112:115], v91 offset:0
  v_mfma_f32_16x16x32_bf16 v[160:163], a[160:163], a[104:107], 0
  buffer_load_dwordx4 v115, s[16:19], s63 offen offset:3072  lds
  v_mfma_f32_16x16x32_bf16 v[164:167], a[164:167], a[104:107], 0
  v_mfma_f32_16x16x32_bf16 v[168:171], a[168:171], a[104:107], 0
  v_mfma_f32_16x16x32_bf16 v[172:175], a[172:175], a[104:107], 0
  s_waitcnt lgkmcnt(4)
  v_mfma_f32_16x16x32_bf16 v[188:191], a[172:175], a[108:111], 0
  v_mfma_f32_16x16x32_bf16 v[184:187], a[168:171], a[108:111], 0
  v_mfma_f32_16x16x32_bf16 v[180:183], a[164:167], a[108:111], 0
  s_waitcnt vmcnt(12) lgkmcnt(0)
  s_barrier
  ds_read_b64_tr_b16 a[224:225], v120 offset:16384
  ds_read_b64_tr_b16 a[226:227], v120 offset:20480
  v_mfma_f32_16x16x32_bf16 v[176:179], a[160:163], a[108:111], 0
  s_add_u32 s63, s42, 3
  ds_read_b128 a[192:195], v92 offset:0
  v_mfma_f32_16x16x32_bf16 v[176:179], a[176:179], a[124:127], v[176:179]
  s_and_b32 s63, s63, 7
  ds_read_b64_tr_b16 a[228:229], v121 offset:16384
  v_mfma_f32_16x16x32_bf16 v[180:183], a[180:183], a[124:127], v[180:183]
  s_lshl_b32 s63, s63, 19
  ds_read_b64_tr_b16 a[230:231], v121 offset:20480
  v_mfma_f32_16x16x32_bf16 v[184:187], a[184:187], a[124:127], v[184:187]
  s_add_u32 m0, s41, 65536
  ds_read_b64_tr_b16 a[232:233], v122 offset:16384
  v_mfma_f32_16x16x32_bf16 v[188:191], a[188:191], a[124:127], v[188:191]
  buffer_load_dwordx4 v112, s[16:19], s63 offen offset:0  lds
  ds_read_b64_tr_b16 a[234:235], v122 offset:20480
  v_mfma_f32_16x16x32_bf16 v[172:175], a[188:191], a[120:123], v[172:175]
  ds_read_b64_tr_b16 a[236:237], v123 offset:16384
  v_mfma_f32_16x16x32_bf16 v[168:171], a[184:187], a[120:123], v[168:171]
  ds_read_b64_tr_b16 a[238:239], v123 offset:20480
  v_mfma_f32_16x16x32_bf16 v[164:167], a[180:183], a[120:123], v[164:167]
  buffer_load_dwordx4 v113, s[16:19], s63 offen offset:1024  lds
  v_mfma_f32_16x16x32_bf16 v[160:163], a[176:179], a[120:123], v[160:163]
  ds_read_b128 a[196:199], v92 offset:4096
  v_mfma_f32_16x16x32_bf16 v[144:147], a[176:179], a[116:119], v[144:147]
  ds_read_b128 a[200:203], v92 offset:8192
  ds_read_b128 a[204:207], v92 offset:12288
  v_mfma_f32_16x16x32_bf16 v[148:151], a[180:183], a[116:119], v[148:151]
  buffer_load_dwordx4 v114, s[16:19], s63 offen offset:2048  lds
  v_mfma_f32_16x16x32_bf16 v[152:155], a[184:187], a[116:119], v[152:155]
  ds_read_b64_tr_b16 a[240:241], v120 offset:24576
  v_mfma_f32_16x16x32_bf16 v[156:159], a[188:191], a[116:119], v[156:159]
  ds_read_b64_tr_b16 a[242:243], v120 offset:28672
  v_mfma_f32_16x16x32_bf16 v[140:143], a[188:191], a[112:115], v[140:143]
  buffer_load_dwordx4 v115, s[16:19], s63 offen offset:3072  lds
  v_mfma_f32_16x16x32_bf16 v[136:139], a[184:187], a[112:115], v[136:139]
  s_add_u32 s63, s63, 256
  ds_read_b128 a[220:223], v93 offset:12288
  ds_read_b64_tr_b16 a[244:245], v121 offset:24576
  v_mfma_f32_16x16x32_bf16 v[132:135], a[180:183], a[112:115], v[132:135]
  s_add_u32 m0, s41, 114688
  ds_read_b64_tr_b16 a[246:247], v121 offset:28672
  v_mfma_f32_16x16x32_bf16 v[128:131], a[176:179], a[112:115], v[128:131]
  s_waitcnt lgkmcnt(8)
  buffer_load_dwordx4 v112, s[16:19], s63 offen offset:0  lds
  v_mfma_f32_16x16x32_bf16 v[128:131], a[224:227], a[192:195], v[128:131]
  ds_read_b64_tr_b16 a[248:249], v122 offset:24576
  v_mfma_f32_16x16x32_bf16 v[132:135], a[228:231], a[192:195], v[132:135]
  ds_read_b64_tr_b16 a[250:251], v122 offset:28672
  v_mfma_f32_16x16x32_bf16 v[136:139], a[232:235], a[192:195], v[136:139]
  buffer_load_dwordx4 v113, s[16:19], s63 offen offset:1024  lds
  ds_read_b64_tr_b16 a[252:253], v123 offset:24576
  v_mfma_f32_16x16x32_bf16 v[140:143], a[236:239], a[192:195], v[140:143]
  s_waitcnt lgkmcnt(7)
  ds_read_b64_tr_b16 a[254:255], v123 offset:28672
  v_mfma_f32_16x16x32_bf16 v[156:159], a[236:239], a[196:199], v[156:159]
  ds_read_b128 a[216:219], v93 offset:8192
  v_mfma_f32_16x16x32_bf16 v[152:155], a[232:235], a[196:199], v[152:155]
  buffer_load_dwordx4 v114, s[16:19], s63 offen offset:2048  lds
  v_mfma_f32_16x16x32_bf16 v[148:151], a[228:231], a[196:199], v[148:151]
  ds_read_b128 a[212:215], v93 offset:4096
  v_mfma_f32_16x16x32_bf16 v[144:147], a[224:227], a[196:199], v[144:147]
  ds_read_b128 a[208:211], v93 offset:0
  v_mfma_f32_16x16x32_bf16 v[160:163], a[224:227], a[200:203], v[160:163]
  buffer_load_dwordx4 v115, s[16:19], s63 offen offset:3072  lds
  v_mfma_f32_16x16x32_bf16 v[164:167], a[228:231], a[200:203], v[164:167]
  v_mfma_f32_16x16x32_bf16 v[168:171], a[232:235], a[200:203], v[168:171]
  v_mfma_f32_16x16x32_bf16 v[172:175], a[236:239], a[200:203], v[172:175]
  v_mfma_f32_16x16x32_bf16 v[188:191], a[236:239], a[204:207], v[188:191]
  v_mfma_f32_16x16x32_bf16 v[184:187], a[232:235], a[204:207], v[184:187]
  v_mfma_f32_16x16x32_bf16 v[180:183], a[228:231], a[204:207], v[180:183]
  s_waitcnt vmcnt(8) lgkmcnt(0)
  s_barrier
  ds_read_b64_tr_b16 a[128:129], v120 offset:32768
  ds_read_b64_tr_b16 a[130:131], v120 offset:36864
  v_mfma_f32_16x16x32_bf16 v[176:179], a[224:227], a[204:207], v[176:179]
  s_add_u32 s63, s42, 4
  ds_read_b128 a[64:67], v90 offset:16384
  v_mfma_f32_16x16x32_bf16 v[176:179], a[240:243], a[220:223], v[176:179]
  s_and_b32 s63, s63, 7
  ds_read_b64_tr_b16 a[132:133], v121 offset:32768
  ds_read_b64_tr_b16 a[134:135], v121 offset:36864
  v_mfma_f32_16x16x32_bf16 v[180:183], a[244:247], a[220:223], v[180:183]
  s_lshl_b32 s63, s63, 19
  ds_read_b64_tr_b16 a[136:137], v122 offset:32768
  v_mfma_f32_16x16x32_bf16 v[184:187], a[248:251], a[220:223], v[184:187]
  s_add_u32 m0, s41, 81920
  ds_read_b64_tr_b16 a[138:139], v122 offset:36864
  v_mfma_f32_16x16x32_bf16 v[188:191], a[252:255], a[220:223], v[188:191]
  buffer_load_dwordx4 v112, s[16:19], s63 offen offset:0  lds
  ds_read_b64_tr_b16 a[140:141], v123 offset:32768
  v_mfma_f32_16x16x32_bf16 v[172:175], a[252:255], a[216:219], v[172:175]
  ds_read_b64_tr_b16 a[142:143], v123 offset:36864
  v_mfma_f32_16x16x32_bf16 v[168:171], a[248:251], a[216:219], v[168:171]
  buffer_load_dwordx4 v113, s[16:19], s63 offen offset:1024  lds
  v_mfma_f32_16x16x32_bf16 v[164:167], a[244:247], a[216:219], v[164:167]
  ds_read_b128 a[68:71], v90 offset:20480
  ds_read_b128 a[72:75], v90 offset:24576
  v_mfma_f32_16x16x32_bf16 v[160:163], a[240:243], a[216:219], v[160:163]
  buffer_load_dwordx4 v114, s[16:19], s63 offen offset:2048  lds
  v_mfma_f32_16x16x32_bf16 v[144:147], a[240:243], a[212:215], v[144:147]
  ds_read_b128 a[76:79], v90 offset:28672
  v_mfma_f32_16x16x32_bf16 v[148:151], a[244:247], a[212:215], v[148:151]
  buffer_load_dwordx4 v115, s[16:19], s63 offen offset:3072  lds
  ds_read_b64_tr_b16 a[144:145], v120 offset:40960
  v_mfma_f32_16x16x32_bf16 v[152:155], a[248:251], a[212:215], v[152:155]
  s_add_u32 s63, s63, 256
  s_add_u32 m0, s41, 131072
  ds_read_b64_tr_b16 a[146:147], v120 offset:45056
  v_mfma_f32_16x16x32_bf16 v[156:159], a[252:255], a[212:215], v[156:159]
  buffer_load_dwordx4 v112, s[16:19], s63 offen offset:0  lds
  v_mfma_f32_16x16x32_bf16 v[140:143], a[252:255], a[208:211], v[140:143]
  ds_read_b128 a[92:95], v91 offset:28672
  ds_read_b64_tr_b16 a[148:149], v121 offset:40960
  v_mfma_f32_16x16x32_bf16 v[136:139], a[248:251], a[208:211], v[136:139]
  buffer_load_dwordx4 v113, s[16:19], s63 offen offset:1024  lds
  v_mfma_f32_16x16x32_bf16 v[132:135], a[244:247], a[208:211], v[132:135]
  ds_read_b64_tr_b16 a[150:151], v121 offset:45056
  v_mfma_f32_16x16x32_bf16 v[128:131], a[240:243], a[208:211], v[128:131]
  s_waitcnt lgkmcnt(6)
  buffer_load_dwordx4 v114, s[16:19], s63 offen offset:2048  lds
  ds_read_b64_tr_b16 a[152:153], v122 offset:40960
  v_mfma_f32_16x16x32_bf16 v[128:131], a[128:131], a[64:67], v[128:131]
  ds_read_b64_tr_b16 a[154:155], v122 offset:45056
  v_mfma_f32_16x16x32_bf16 v[132:135], a[132:135], a[64:67], v[132:135]
  buffer_load_dwordx4 v115, s[16:19], s63 offen offset:3072  lds
  v_mfma_f32_16x16x32_bf16 v[136:139], a[136:139], a[64:67], v[136:139]
  s_add_u32 s47, s42, 4
  s_and_b32 s47, s47, 7
  s_lshl_b32 s47, s47, 7
  s_add_u32 m0, s41, 32768
  ds_read_b64_tr_b16 a[156:157], v123 offset:40960
  ds_read_b64_tr_b16 a[158:159], v123 offset:45056
  v_mfma_f32_16x16x32_bf16 v[140:143], a[140:143], a[64:67], v[140:143]
  buffer_load_dwordx4 v104, s[4:7], s47 offen offset:0  lds
  v_mfma_f32_16x16x32_bf16 v[156:159], a[140:143], a[68:71], v[156:159]
  ds_read_b128 a[88:91], v91 offset:24576
  v_mfma_f32_16x16x32_bf16 v[152:155], a[136:139], a[68:71], v[152:155]
  buffer_load_dwordx4 v105, s[4:7], s47 offen offset:1024  lds
  ds_read_b128 a[84:87], v91 offset:20480
  v_mfma_f32_16x16x32_bf16 v[148:151], a[132:135], a[68:71], v[148:151]
  ds_read_b128 a[80:83], v91 offset:16384
  v_mfma_f32_16x16x32_bf16 v[144:147], a[128:131], a[68:71], v[144:147]
  buffer_load_dwordx4 v106, s[4:7], s47 offen offset:2048  lds
  v_mfma_f32_16x16x32_bf16 v[160:163], a[128:131], a[72:75], v[160:163]
  v_mfma_f32_16x16x32_bf16 v[164:167], a[132:135], a[72:75], v[164:167]
  buffer_load_dwordx4 v107, s[4:7], s47 offen offset:3072  lds
  v_mfma_f32_16x16x32_bf16 v[168:171], a[136:139], a[72:75], v[168:171]
  v_mfma_f32_16x16x32_bf16 v[172:175], a[140:143], a[72:75], v[172:175]
  s_waitcnt lgkmcnt(3)
  v_mfma_f32_16x16x32_bf16 v[188:191], a[140:143], a[76:79], v[188:191]
  v_mfma_f32_16x16x32_bf16 v[184:187], a[136:139], a[76:79], v[184:187]
  v_mfma_f32_16x16x32_bf16 v[180:183], a[132:135], a[76:79], v[180:183]
  s_waitcnt vmcnt(12) lgkmcnt(0)
  s_barrier
  ds_read_b64_tr_b16 a[160:161], v120 offset:0
  ds_read_b64_tr_b16 a[162:163], v120 offset:4096
  v_mfma_f32_16x16x32_bf16 v[176:179], a[128:131], a[76:79], v[176:179]
  s_add_u32 s63, s42, 5
  ds_read_b128 a[96:99], v92 offset:16384
  v_mfma_f32_16x16x32_bf16 v[176:179], a[144:147], a[92:95], v[176:179]
  s_and_b32 s63, s63, 7
  ds_read_b64_tr_b16 a[164:165], v121 offset:0
  ds_read_b64_tr_b16 a[166:167], v121 offset:4096
  v_mfma_f32_16x16x32_bf16 v[180:183], a[148:151], a[92:95], v[180:183]
  s_lshl_b32 s63, s63, 19
  ds_read_b64_tr_b16 a[168:169], v122 offset:0
  v_mfma_f32_16x16x32_bf16 v[184:187], a[152:155], a[92:95], v[184:187]
  s_add_u32 m0, s41, 98304
  ds_read_b64_tr_b16 a[170:171], v122 offset:4096
  v_mfma_f32_16x16x32_bf16 v[188:191], a[156:159], a[92:95], v[188:191]
  buffer_load_dwordx4 v112, s[16:19], s63 offen offset:0  lds
  ds_read_b64_tr_b16 a[172:173], v123 offset:0
  v_mfma_f32_16x16x32_bf16 v[172:175], a[156:159], a[88:91], v[172:175]
  ds_read_b64_tr_b16 a[174:175], v123 offset:4096
  v_mfma_f32_16x16x32_bf16 v[168:171], a[152:155], a[88:91], v[168:171]
  buffer_load_dwordx4 v113, s[16:19], s63 offen offset:1024  lds
  v_mfma_f32_16x16x32_bf16 v[164:167], a[148:151], a[88:91], v[164:167]
  ds_read_b128 a[100:103], v92 offset:20480
  ds_read_b128 a[104:107], v92 offset:24576
  v_mfma_f32_16x16x32_bf16 v[160:163], a[144:147], a[88:91], v[160:163]
  buffer_load_dwordx4 v114, s[16:19], s63 offen offset:2048  lds
  v_mfma_f32_16x16x32_bf16 v[144:147], a[144:147], a[84:87], v[144:147]
  ds_read_b128 a[108:111], v92 offset:28672
  v_mfma_f32_16x16x32_bf16 v[148:151], a[148:151], a[84:87], v[148:151]
  buffer_load_dwordx4 v115, s[16:19], s63 offen offset:3072  lds
  ds_read_b64_tr_b16 a[176:177], v120 offset:8192
  v_mfma_f32_16x16x32_bf16 v[152:155], a[152:155], a[84:87], v[152:155]
  s_add_u32 s63, s63, 256
  s_add_u32 m0, s41, 147456
  ds_read_b64_tr_b16 a[178:179], v120 offset:12288
  v_mfma_f32_16x16x32_bf16 v[156:159], a[156:159], a[84:87], v[156:159]
  buffer_load_dwordx4 v112, s[16:19], s63 offen offset:0  lds
  v_mfma_f32_16x16x32_bf16 v[140:143], a[156:159], a[80:83], v[140:143]
  ds_read_b128 a[124:127], v93 offset:28672
  ds_read_b64_tr_b16 a[180:181], v121 offset:8192
  v_mfma_f32_16x16x32_bf16 v[136:139], a[152:155], a[80:83], v[136:139]
  buffer_load_dwordx4 v113, s[16:19], s63 offen offset:1024  lds
  v_mfma_f32_16x16x32_bf16 v[132:135], a[148:151], a[80:83], v[132:135]
  ds_read_b64_tr_b16 a[182:183], v121 offset:12288
  v_mfma_f32_16x16x32_bf16 v[128:131], a[144:147], a[80:83], v[128:131]
  s_waitcnt lgkmcnt(6)
  buffer_load_dwordx4 v114, s[16:19], s63 offen offset:2048  lds
  ds_read_b64_tr_b16 a[184:185], v122 offset:8192
  v_mfma_f32_16x16x32_bf16 v[128:131], a[160:163], a[96:99], v[128:131]
  ds_read_b64_tr_b16 a[186:187], v122 offset:12288
  v_mfma_f32_16x16x32_bf16 v[132:135], a[164:167], a[96:99], v[132:135]
  buffer_load_dwordx4 v115, s[16:19], s63 offen offset:3072  lds
  v_mfma_f32_16x16x32_bf16 v[136:139], a[168:171], a[96:99], v[136:139]
  s_and_b32 m0, s41, 0xffff
  ds_read_b64_tr_b16 a[188:189], v123 offset:8192
  ds_read_b64_tr_b16 a[190:191], v123 offset:12288
  v_mfma_f32_16x16x32_bf16 v[140:143], a[172:175], a[96:99], v[140:143]
  buffer_load_dwordx4 v16, s[8:11], s43 offen offset:0  lds
  v_mfma_f32_16x16x32_bf16 v[156:159], a[172:175], a[100:103], v[156:159]
  ds_read_b128 a[120:123], v93 offset:24576
  v_mfma_f32_16x16x32_bf16 v[152:155], a[168:171], a[100:103], v[152:155]
  buffer_load_dwordx4 v17, s[8:11], s43 offen offset:1024  lds
  ds_read_b128 a[116:119], v93 offset:20480
  v_mfma_f32_16x16x32_bf16 v[148:151], a[164:167], a[100:103], v[148:151]
  ds_read_b128 a[112:115], v93 offset:16384
  v_mfma_f32_16x16x32_bf16 v[144:147], a[160:163], a[100:103], v[144:147]
  buffer_load_dwordx4 v18, s[8:11], s43 offen offset:2048  lds
  v_mfma_f32_16x16x32_bf16 v[160:163], a[160:163], a[104:107], v[160:163]
  v_mfma_f32_16x16x32_bf16 v[164:167], a[164:167], a[104:107], v[164:167]
  buffer_load_dwordx4 v19, s[8:11], s43 offen offset:3072  lds
  v_mfma_f32_16x16x32_bf16 v[168:171], a[168:171], a[104:107], v[168:171]
  v_mfma_f32_16x16x32_bf16 v[172:175], a[172:175], a[104:107], v[172:175]
  s_waitcnt lgkmcnt(3)
  v_mfma_f32_16x16x32_bf16 v[188:191], a[172:175], a[108:111], v[188:191]
  v_mfma_f32_16x16x32_bf16 v[184:187], a[168:171], a[108:111], v[184:187]
  v_mfma_f32_16x16x32_bf16 v[180:183], a[164:167], a[108:111], v[180:183]
  s_waitcnt vmcnt(12) lgkmcnt(0)
  s_barrier
  ds_read_b64_tr_b16 a[224:225], v120 offset:16384
  ds_read_b64_tr_b16 a[226:227], v120 offset:20480
  v_mfma_f32_16x16x32_bf16 v[176:179], a[160:163], a[108:111], v[176:179]
  s_add_u32 s63, s42, 6
  ds_read_b128 a[192:195], v90 offset:32768
  v_mfma_f32_16x16x32_bf16 v[176:179], a[176:179], a[124:127], v[176:179]
  s_and_b32 s63, s63, 7
  ds_read_b64_tr_b16 a[228:229], v121 offset:16384
  ds_read_b64_tr_b16 a[230:231], v121 offset:20480
  v_mfma_f32_16x16x32_bf16 v[180:183], a[180:183], a[124:127], v[180:183]
  s_lshl_b32 s63, s63, 19
  ds_read_b64_tr_b16 a[232:233], v122 offset:16384
  v_mfma_f32_16x16x32_bf16 v[184:187], a[184:187], a[124:127], v[184:187]
  s_add_u32 m0, s41, 65536
  ds_read_b64_tr_b16 a[234:235], v122 offset:20480
  v_mfma_f32_16x16x32_bf16 v[188:191], a[188:191], a[124:127], v[188:191]
  buffer_load_dwordx4 v112, s[16:19], s63 offen offset:0  lds
  ds_read_b64_tr_b16 a[236:237], v123 offset:16384
  v_mfma_f32_16x16x32_bf16 v[172:175], a[188:191], a[120:123], v[172:175]
  ds_read_b64_tr_b16 a[238:239], v123 offset:20480
  v_mfma_f32_16x16x32_bf16 v[168:171], a[184:187], a[120:123], v[168:171]
  buffer_load_dwordx4 v113, s[16:19], s63 offen offset:1024  lds
  v_mfma_f32_16x16x32_bf16 v[164:167], a[180:183], a[120:123], v[164:167]
  ds_read_b128 a[196:199], v90 offset:36864
  ds_read_b128 a[200:203], v90 offset:40960
  v_mfma_f32_16x16x32_bf16 v[160:163], a[176:179], a[120:123], v[160:163]
  buffer_load_dwordx4 v114, s[16:19], s63 offen offset:2048  lds
  v_mfma_f32_16x16x32_bf16 v[144:147], a[176:179], a[116:119], v[144:147]
  ds_read_b128 a[204:207], v90 offset:45056
  v_mfma_f32_16x16x32_bf16 v[148:151], a[180:183], a[116:119], v[148:151]
  buffer_load_dwordx4 v115, s[16:19], s63 offen offset:3072  lds
  ds_read_b64_tr_b16 a[240:241], v120 offset:24576
  v_mfma_f32_16x16x32_bf16 v[152:155], a[184:187], a[116:119], v[152:155]
  s_add_u32 s63, s63, 256
  s_add_u32 m0, s41, 114688
  ds_read_b64_tr_b16 a[242:243], v120 offset:28672
  v_mfma_f32_16x16x32_bf16 v[156:159], a[188:191], a[116:119], v[156:159]
  buffer_load_dwordx4 v112, s[16:19], s63 offen offset:0  lds
  v_mfma_f32_16x16x32_bf16 v[140:143], a[188:191], a[112:115], v[140:143]
  ds_read_b128 a[220:223], v91 offset:45056
  ds_read_b64_tr_b16 a[244:245], v121 offset:24576
  v_mfma_f32_16x16x32_bf16 v[136:139], a[184:187], a[112:115], v[136:139]
  buffer_load_dwordx4 v113, s[16:19], s63 offen offset:1024  lds
  v_mfma_f32_16x16x32_bf16 v[132:135], a[180:183], a[112:115], v[132:135]
  ds_read_b64_tr_b16 a[246:247], v121 offset:28672
  v_mfma_f32_16x16x32_bf16 v[128:131], a[176:179], a[112:115], v[128:131]
  s_waitcnt lgkmcnt(6)
  buffer_load_dwordx4 v114, s[16:19], s63 offen offset:2048  lds
  ds_read_b64_tr_b16 a[248:249], v122 offset:24576
  v_mfma_f32_16x16x32_bf16 v[128:131], a[224:227], a[192:195], v[128:131]
  ds_read_b64_tr_b16 a[250:251], v122 offset:28672
  v_mfma_f32_16x16x32_bf16 v[132:135], a[228:231], a[192:195], v[132:135]
  buffer_load_dwordx4 v115, s[16:19], s63 offen offset:3072  lds
  v_mfma_f32_16x16x32_bf16 v[136:139], a[232:235], a[192:195], v[136:139]
  s_add_u32 s47, s42, 6
  s_and_b32 s47, s47, 7
  s_lshl_b32 s47, s47, 7
  s_add_u32 m0, s41, 49152
  ds_read_b64_tr_b16 a[252:253], v123 offset:24576
  ds_read_b64_tr_b16 a[254:255], v123 offset:28672
  v_mfma_f32_16x16x32_bf16 v[140:143], a[236:239], a[192:195], v[140:143]
  buffer_load_dwordx4 v104, s[4:7], s47 offen offset:0  lds
  v_mfma_f32_16x16x32_bf16 v[156:159], a[236:239], a[196:199], v[156:159]
  ds_read_b128 a[216:219], v91 offset:40960
  v_mfma_f32_16x16x32_bf16 v[152:155], a[232:235], a[196:199], v[152:155]
  buffer_load_dwordx4 v105, s[4:7], s47 offen offset:1024  lds
  ds_read_b128 a[212:215], v91 offset:36864
  v_mfma_f32_16x16x32_bf16 v[148:151], a[228:231], a[196:199], v[148:151]
  ds_read_b128 a[208:211], v91 offset:32768
  v_mfma_f32_16x16x32_bf16 v[144:147], a[224:227], a[196:199], v[144:147]
  buffer_load_dwordx4 v106, s[4:7], s47 offen offset:2048  lds
  v_mfma_f32_16x16x32_bf16 v[160:163], a[224:227], a[200:203], v[160:163]
  v_mfma_f32_16x16x32_bf16 v[164:167], a[228:231], a[200:203], v[164:167]
  buffer_load_dwordx4 v107, s[4:7], s47 offen offset:3072  lds
  v_mfma_f32_16x16x32_bf16 v[168:171], a[232:235], a[200:203], v[168:171]
  v_mfma_f32_16x16x32_bf16 v[172:175], a[236:239], a[200:203], v[172:175]
  s_waitcnt lgkmcnt(3)
  v_mfma_f32_16x16x32_bf16 v[188:191], a[236:239], a[204:207], v[188:191]
  v_mfma_f32_16x16x32_bf16 v[184:187], a[232:235], a[204:207], v[184:187]
  v_mfma_f32_16x16x32_bf16 v[180:183], a[228:231], a[204:207], v[180:183]
  s_waitcnt vmcnt(16) lgkmcnt(0)
  s_barrier
  ds_read_b64_tr_b16 a[128:129], v120 offset:32768
  ds_read_b64_tr_b16 a[130:131], v120 offset:36864
  v_mfma_f32_16x16x32_bf16 v[176:179], a[224:227], a[204:207], v[176:179]
  s_add_u32 s63, s42, 7
  ds_read_b128 a[64:67], v92 offset:32768
  v_mfma_f32_16x16x32_bf16 v[176:179], a[240:243], a[220:223], v[176:179]
  s_and_b32 s63, s63, 7
  ds_read_b64_tr_b16 a[132:133], v121 offset:32768
  ds_read_b64_tr_b16 a[134:135], v121 offset:36864
  v_mfma_f32_16x16x32_bf16 v[180:183], a[244:247], a[220:223], v[180:183]
  s_lshl_b32 s63, s63, 19
  ds_read_b64_tr_b16 a[136:137], v122 offset:32768
  v_mfma_f32_16x16x32_bf16 v[184:187], a[248:251], a[220:223], v[184:187]
  s_add_u32 m0, s41, 81920
  ds_read_b64_tr_b16 a[138:139], v122 offset:36864
  v_mfma_f32_16x16x32_bf16 v[188:191], a[252:255], a[220:223], v[188:191]
  buffer_load_dwordx4 v112, s[16:19], s63 offen offset:0  lds
  ds_read_b64_tr_b16 a[140:141], v123 offset:32768
  v_mfma_f32_16x16x32_bf16 v[172:175], a[252:255], a[216:219], v[172:175]
  ds_read_b64_tr_b16 a[142:143], v123 offset:36864
  v_mfma_f32_16x16x32_bf16 v[168:171], a[248:251], a[216:219], v[168:171]
  buffer_load_dwordx4 v113, s[16:19], s63 offen offset:1024  lds
  v_mfma_f32_16x16x32_bf16 v[164:167], a[244:247], a[216:219], v[164:167]
  ds_read_b128 a[68:71], v92 offset:36864
  ds_read_b128 a[72:75], v92 offset:40960
  v_mfma_f32_16x16x32_bf16 v[160:163], a[240:243], a[216:219], v[160:163]
  buffer_load_dwordx4 v114, s[16:19], s63 offen offset:2048  lds
  v_mfma_f32_16x16x32_bf16 v[144:147], a[240:243], a[212:215], v[144:147]
  ds_read_b128 a[76:79], v92 offset:45056
  v_mfma_f32_16x16x32_bf16 v[148:151], a[244:247], a[212:215], v[148:151]
  buffer_load_dwordx4 v115, s[16:19], s63 offen offset:3072  lds
  ds_read_b64_tr_b16 a[144:145], v120 offset:40960
  v_mfma_f32_16x16x32_bf16 v[152:155], a[248:251], a[212:215], v[152:155]
  s_add_u32 s63, s63, 256
  s_add_u32 m0, s41, 131072
  ds_read_b64_tr_b16 a[146:147], v120 offset:45056
  v_mfma_f32_16x16x32_bf16 v[156:159], a[252:255], a[212:215], v[156:159]
  buffer_load_dwordx4 v112, s[16:19], s63 offen offset:0  lds
  v_mfma_f32_16x16x32_bf16 v[140:143], a[252:255], a[208:211], v[140:143]
  ds_read_b128 a[92:95], v93 offset:45056
  ds_read_b64_tr_b16 a[148:149], v121 offset:40960
  v_mfma_f32_16x16x32_bf16 v[136:139], a[248:251], a[208:211], v[136:139]
  buffer_load_dwordx4 v113, s[16:19], s63 offen offset:1024  lds
  v_mfma_f32_16x16x32_bf16 v[132:135], a[244:247], a[208:211], v[132:135]
  ds_read_b64_tr_b16 a[150:151], v121 offset:45056
  v_mfma_f32_16x16x32_bf16 v[128:131], a[240:243], a[208:211], v[128:131]
  s_waitcnt lgkmcnt(6)
  buffer_load_dwordx4 v114, s[16:19], s63 offen offset:2048  lds
  ds_read_b64_tr_b16 a[152:153], v122 offset:40960
  v_mfma_f32_16x16x32_bf16 v[128:131], a[128:131], a[64:67], v[128:131]
  ds_read_b64_tr_b16 a[154:155], v122 offset:45056
  v_mfma_f32_16x16x32_bf16 v[132:135], a[132:135], a[64:67], v[132:135]
  buffer_load_dwordx4 v115, s[16:19], s63 offen offset:3072  lds
  v_mfma_f32_16x16x32_bf16 v[136:139], a[136:139], a[64:67], v[136:139]
  s_sub_u32 s43, s43, s57
  s_and_b32 s43, s43, s57
  s_add_u32 m0, s41, 16384
  ds_read_b64_tr_b16 a[156:157], v123 offset:40960
  ds_read_b64_tr_b16 a[158:159], v123 offset:45056
  v_mfma_f32_16x16x32_bf16 v[140:143], a[140:143], a[64:67], v[140:143]
  buffer_load_dwordx4 v16, s[8:11], s43 offen offset:0  lds
  v_mfma_f32_16x16x32_bf16 v[156:159], a[140:143], a[68:71], v[156:159]
  ds_read_b128 a[88:91], v93 offset:40960
  v_mfma_f32_16x16x32_bf16 v[152:155], a[136:139], a[68:71], v[152:155]
  buffer_load_dwordx4 v17, s[8:11], s43 offen offset:1024  lds
  ds_read_b128 a[84:87], v93 offset:36864
  v_mfma_f32_16x16x32_bf16 v[148:151], a[132:135], a[68:71], v[148:151]
  ds_read_b128 a[80:83], v93 offset:32768
  v_mfma_f32_16x16x32_bf16 v[144:147], a[128:131], a[68:71], v[144:147]
  buffer_load_dwordx4 v18, s[8:11], s43 offen offset:2048  lds
  v_mfma_f32_16x16x32_bf16 v[160:163], a[128:131], a[72:75], v[160:163]
  v_mfma_f32_16x16x32_bf16 v[164:167], a[132:135], a[72:75], v[164:167]
  buffer_load_dwordx4 v19, s[8:11], s43 offen offset:3072  lds
  v_mfma_f32_16x16x32_bf16 v[168:171], a[136:139], a[72:75], v[168:171]
  v_mfma_f32_16x16x32_bf16 v[172:175], a[140:143], a[72:75], v[172:175]
  s_waitcnt lgkmcnt(3)
  v_mfma_f32_16x16x32_bf16 v[188:191], a[140:143], a[76:79], v[188:191]
  v_mfma_f32_16x16x32_bf16 v[184:187], a[136:139], a[76:79], v[184:187]
  v_mfma_f32_16x16x32_bf16 v[180:183], a[132:135], a[76:79], v[180:183]
  s_waitcnt vmcnt(12) lgkmcnt(0)
  s_barrier
  ds_read_b64_tr_b16 a[160:161], v120 offset:0
  ds_read_b64_tr_b16 a[162:163], v120 offset:4096
  v_mfma_f32_16x16x32_bf16 v[176:179], a[128:131], a[76:79], v[176:179]
  s_add_u32 m0, s41, 98304
  ds_read_b128 a[96:99], v90 offset:49152
  v_mfma_f32_16x16x32_bf16 v[176:179], a[144:147], a[92:95], v[176:179]
  buffer_load_dwordx4 v20, s[12:15], s44 offen offset:0  lds
  ds_read_b64_tr_b16 a[164:165], v121 offset:0
  v_mfma_f32_16x16x32_bf16 v[180:183], a[148:151], a[92:95], v[180:183]
  ds_read_b64_tr_b16 a[166:167], v121 offset:4096
  v_mfma_f32_16x16x32_bf16 v[184:187], a[152:155], a[92:95], v[184:187]
  ds_read_b64_tr_b16 a[168:169], v122 offset:0
  v_mfma_f32_16x16x32_bf16 v[188:191], a[156:159], a[92:95], v[188:191]
  ds_read_b64_tr_b16 a[170:171], v122 offset:4096
  ds_read_b64_tr_b16 a[172:173], v123 offset:0
  v_mfma_f32_16x16x32_bf16 v[172:175], a[156:159], a[88:91], v[172:175]
  ds_read_b64_tr_b16 a[174:175], v123 offset:4096
  v_mfma_f32_16x16x32_bf16 v[168:171], a[152:155], a[88:91], v[168:171]
  buffer_load_dwordx4 v21, s[12:15], s44 offen offset:1024  lds
  ds_read_b128 a[100:103], v90 offset:53248
  v_mfma_f32_16x16x32_bf16 v[164:167], a[148:151], a[88:91], v[164:167]
  ds_read_b128 a[104:107], v90 offset:57344
  v_mfma_f32_16x16x32_bf16 v[160:163], a[144:147], a[88:91], v[160:163]
  ds_read_b64_tr_b16 a[188:189], v123 offset:8192
  v_mfma_f32_16x16x32_bf16 v[144:147], a[144:147], a[84:87], v[144:147]
  ds_read_b64_tr_b16 a[190:191], v123 offset:12288
  ds_read_b128 a[120:123], v91 offset:57344
  v_mfma_f32_16x16x32_bf16 v[148:151], a[148:151], a[84:87], v[148:151]
  ds_read_b64_tr_b16 a[184:185], v122 offset:8192
  v_mfma_f32_16x16x32_bf16 v[152:155], a[152:155], a[84:87], v[152:155]
  ds_read_b64_tr_b16 a[186:187], v122 offset:12288
  ds_read_b64_tr_b16 a[180:181], v121 offset:8192
  v_mfma_f32_16x16x32_bf16 v[156:159], a[156:159], a[84:87], v[156:159]
  buffer_load_dwordx4 v20, s[12:15], s44 offen offset:2048  lds
  v_mfma_f32_16x16x32_bf16 v[140:143], a[156:159], a[80:83], v[140:143]
  ds_read_b64_tr_b16 a[182:183], v121 offset:12288
  v_mfma_f32_16x16x32_bf16 v[136:139], a[152:155], a[80:83], v[136:139]
  ds_read_b64_tr_b16 a[176:177], v120 offset:8192
  ds_read_b64_tr_b16 a[178:179], v120 offset:12288
  v_mfma_f32_16x16x32_bf16 v[132:135], a[148:151], a[80:83], v[132:135]
  ds_read_b128 a[116:119], v91 offset:53248
  v_mfma_f32_16x16x32_bf16 v[128:131], a[144:147], a[80:83], v[128:131]
  s_waitcnt lgkmcnt(10)
  ds_read_b128 a[112:115], v91 offset:49152
  v_mfma_f32_16x16x32_bf16 v[128:131], a[160:163], a[96:99], v[128:131]
  buffer_load_dwordx4 v21, s[12:15], s44 offen offset:3072  lds
  v_mfma_f32_16x16x32_bf16 v[132:135], a[164:167], a[96:99], v[132:135]
  v_mfma_f32_16x16x32_bf16 v[136:139], a[168:171], a[96:99], v[136:139]
  v_mfma_f32_16x16x32_bf16 v[140:143], a[172:175], a[96:99], v[140:143]
  v_mfma_f32_16x16x32_bf16 v[156:159], a[172:175], a[100:103], v[156:159]
  v_mfma_f32_16x16x32_bf16 v[152:155], a[168:171], a[100:103], v[152:155]
  v_mfma_f32_16x16x32_bf16 v[148:151], a[164:167], a[100:103], v[148:151]
  s_waitcnt vmcnt(8) lgkmcnt(0)
  s_barrier
  ds_read_b128 a[192:195], v92 offset:49152
  ds_read_b128 a[208:211], v93 offset:49152
  v_mfma_f32_16x16x32_bf16 v[144:147], a[160:163], a[100:103], v[144:147]
L_w0:
  s_cbranch_execz L_w4
  s_sub_u32 s44, s44, s57
  ds_read_b64_tr_b16 a[224:225], v120 offset:16384
  ds_read_b64_tr_b16 a[226:227], v120 offset:20480
  v_mfma_f32_16x16x32_bf16 v[160:163], a[160:163], a[104:107], v[160:163]
  s_and_b32 s44, s44, s57
  ds_read_b64_tr_b16 a[240:241], v120 offset:24576
  v_mfma_f32_16x16x32_bf16 v[164:167], a[164:167], a[104:107], v[164:167]
  s_add_u32 m0, s41, 114688
  ds_read_b64_tr_b16 a[242:243], v120 offset:28672
  ds_read_b64_tr_b16 a[228:229], v121 offset:16384
  v_mfma_f32_16x16x32_bf16 v[168:171], a[168:171], a[104:107], v[168:171]
  buffer_load_dwordx4 v20, s[12:15], s44 offen offset:0  lds
  v_mfma_f32_16x16x32_bf16 v[172:175], a[172:175], a[104:107], v[172:175]
  ds_read_b64_tr_b16 a[230:231], v121 offset:20480
  ds_read_b64_tr_b16 a[244:245], v121 offset:24576
  v_mfma_f32_16x16x32_bf16 v[172:175], a[188:191], a[120:123], v[172:175]
  ds_read_b64_tr_b16 a[246:247], v121 offset:28672
  v_mfma_f32_16x16x32_bf16 v[168:171], a[184:187], a[120:123], v[168:171]
  ds_read_b64_tr_b16 a[232:233], v122 offset:16384
  ds_read_b64_tr_b16 a[234:235], v122 offset:20480
  v_mfma_f32_16x16x32_bf16 v[164:167], a[180:183], a[120:123], v[164:167]
  ds_read_b64_tr_b16 a[248:249], v122 offset:24576
  v_mfma_f32_16x16x32_bf16 v[160:163], a[176:179], a[120:123], v[160:163]
  ds_read_b64_tr_b16 a[250:251], v122 offset:28672
  ds_read_b64_tr_b16 a[236:237], v123 offset:16384
  v_mfma_f32_16x16x32_bf16 v[144:147], a[176:179], a[116:119], v[144:147]
  buffer_load_dwordx4 v21, s[12:15], s44 offen offset:1024  lds
  v_mfma_f32_16x16x32_bf16 v[148:151], a[180:183], a[116:119], v[148:151]
  ds_read_b64_tr_b16 a[238:239], v123 offset:20480
  ds_read_b64_tr_b16 a[252:253], v123 offset:24576
  v_mfma_f32_16x16x32_bf16 v[152:155], a[184:187], a[116:119], v[152:155]
  ds_read_b64_tr_b16 a[254:255], v123 offset:28672
  v_mfma_f32_16x16x32_bf16 v[156:159], a[188:191], a[116:119], v[156:159]
  ds_read_b128 a[196:199], v92 offset:53248
  ds_read_b128 a[212:215], v93 offset:53248
  v_mfma_f32_16x16x32_bf16 v[140:143], a[188:191], a[112:115], v[140:143]
  ds_read_b128 a[200:203], v92 offset:57344
  v_mfma_f32_16x16x32_bf16 v[136:139], a[184:187], a[112:115], v[136:139]
  ds_read_b128 a[216:219], v93 offset:57344
  ds_read_b128 a[204:207], v92 offset:61440
  v_mfma_f32_16x16x32_bf16 v[132:135], a[180:183], a[112:115], v[132:135]
  buffer_load_dwordx4 v20, s[12:15], s44 offen offset:2048  lds
  v_mfma_f32_16x16x32_bf16 v[128:131], a[176:179], a[112:115], v[128:131]
  s_waitcnt lgkmcnt(10)
  ds_read_b128 a[220:223], v93 offset:61440
  ds_read_b128 a[108:111], v90 offset:61440
  v_mfma_f32_16x16x32_bf16 v[128:131], a[224:227], a[192:195], v[128:131]
  ds_read_b128 a[124:127], v91 offset:61440
  v_mfma_f32_16x16x32_bf16 v[128:131], a[240:243], a[208:211], v[128:131]
  v_mfma_f32_16x16x32_bf16 v[132:135], a[228:231], a[192:195], v[132:135]
  v_mfma_f32_16x16x32_bf16 v[132:135], a[244:247], a[208:211], v[132:135]
  v_mfma_f32_16x16x32_bf16 v[136:139], a[232:235], a[192:195], v[136:139]
  s_waitcnt lgkmcnt(6)
  buffer_load_dwordx4 v21, s[12:15], s44 offen offset:3072  lds
  v_mfma_f32_16x16x32_bf16 v[136:139], a[248:251], a[208:211], v[136:139]
  s_nop 1
  v_mul_f32 v128, s68, v128
  v_mul_f32 v129, s68, v129
  v_mfma_f32_16x16x32_bf16 v[140:143], a[236:239], a[192:195], v[140:143]
  s_waitcnt lgkmcnt(0)
  v_mul_f32 v130, s68, v130
  v_mul_f32_e64 v131, s68, v131
  v_mfma_f32_16x16x32_bf16 v[140:143], a[252:255], a[208:211], v[140:143]
  s_barrier
  v_cvt_pk_bf16_f32 v128, v128, v129
  v_cvt_pk_bf16_f32 v129, v130, v131
  v_mfma_f32_16x16x32_bf16 v[144:147], a[224:227], a[196:199], v[144:147]
  ds_write_b64 v98, v[128:129] offset:0
  v_mul_f32 v132, s68, v132
  v_mfma_f32_16x16x32_bf16 v[144:147], a[240:243], a[212:215], v[144:147]
  v_mul_f32 v133, s68, v133
  v_mul_f32 v134, s68, v134
  v_mfma_f32_16x16x32_bf16 v[148:151], a[228:231], a[196:199], v[148:151]
  s_sub_u32 s43, s43, s57
  v_mul_f32 v135, s68, v135
  v_cvt_pk_bf16_f32 v132, v132, v133
  v_mfma_f32_16x16x32_bf16 v[148:151], a[244:247], a[212:215], v[148:151]
  s_and_b32 s43, s43, s57
  v_cvt_pk_bf16_f32 v133, v134, v135
  v_mul_f32 v136, s68, v136
  v_mfma_f32_16x16x32_bf16 v[152:155], a[232:235], a[196:199], v[152:155]
  s_add_u32 m0, s41, 32768
  ds_write_b64 v98, v[132:133] offset:512
  v_mul_f32_e64 v137, s68, v137
  v_mfma_f32_16x16x32_bf16 v[152:155], a[248:251], a[212:215], v[152:155]
  buffer_load_dwordx4 v16, s[8:11], s43 offen offset:0  lds
  v_mul_f32_e64 v138, s68, v138
  v_mfma_f32_16x16x32_bf16 v[156:159], a[236:239], a[196:199], v[156:159]
  v_mul_f32_e64 v139, s68, v139
  v_cvt_pk_bf16_f32 v136, v136, v137
  v_mfma_f32_16x16x32_bf16 v[156:159], a[252:255], a[212:215], v[156:159]
  v_cvt_pk_bf16_f32 v137, v138, v139
  v_mul_f32_e64 v140, s68, v140
  v_mfma_f32_16x16x32_bf16 v[160:163], a[224:227], a[200:203], v[160:163]
  buffer_load_dwordx4 v17, s[8:11], s43 offen offset:1024  lds
  v_mul_f32_e64 v141, s68, v141
  v_mfma_f32_16x16x32_bf16 v[160:163], a[240:243], a[216:219], v[160:163]
  ds_write_b64 v98, v[136:137] offset:1024
  v_mul_f32_e64 v142, s68, v142
  v_mfma_f32_16x16x32_bf16 v[164:167], a[228:231], a[200:203], v[164:167]
  v_mul_f32_e64 v143, s68, v143
  v_cvt_pk_bf16_f32 v140, v140, v141
  v_mfma_f32_16x16x32_bf16 v[164:167], a[244:247], a[216:219], v[164:167]
  buffer_load_dwordx4 v18, s[8:11], s43 offen offset:2048  lds
  v_cvt_pk_bf16_f32 v141, v142, v143
  v_mfma_f32_16x16x32_bf16 v[168:171], a[232:235], a[200:203], v[168:171]
  ds_write_b64 v98, v[140:141] offset:1536
  v_mul_f32_e64 v144, s68, v144
  v_mfma_f32_16x16x32_bf16 v[168:171], a[248:251], a[216:219], v[168:171]
  v_mul_f32 v145, s68, v145
  v_mul_f32 v146, s68, v146
  v_mfma_f32_16x16x32_bf16 v[172:175], a[236:239], a[200:203], v[172:175]
  v_mul_f32_e64 v147, s68, v147
  v_cvt_pk_bf16_f32 v144, v144, v145
  v_mfma_f32_16x16x32_bf16 v[172:175], a[252:255], a[216:219], v[172:175]
  buffer_load_dwordx4 v19, s[8:11], s43 offen offset:3072  lds
  v_cvt_pk_bf16_f32 v145, v146, v147
  v_mfma_f32_16x16x32_bf16 v[176:179], a[160:163], a[108:111], v[176:179]
  s_sub_u32 s44, s44, s57
  s_and_b32 s44, s44, s57
  ds_write_b64 v98, v[144:145] offset:4096
  v_mul_f32_e64 v148, s68, v148
  v_mfma_f32_16x16x32_bf16 v[176:179], a[176:179], a[124:127], v[176:179]
  s_add_u32 m0, s41, 65536
  v_mul_f32 v149, s68, v149
  v_mul_f32 v150, s68, v150
  v_mfma_f32_16x16x32_bf16 v[176:179], a[224:227], a[204:207], v[176:179]
  buffer_load_dwordx4 v20, s[12:15], s44 offen offset:0  lds
  v_mul_f32_e64 v151, s68, v151
  v_mfma_f32_16x16x32_bf16 v[176:179], a[240:243], a[220:223], v[176:179]
  v_cvt_pk_bf16_f32 v148, v148, v149
  v_cvt_pk_bf16_f32 v149, v150, v151
  v_mfma_f32_16x16x32_bf16 v[180:183], a[164:167], a[108:111], v[180:183]
  ds_write_b64 v98, v[148:149] offset:4608
  v_mul_f32_e64 v152, s68, v152
  v_mfma_f32_16x16x32_bf16 v[180:183], a[180:183], a[124:127], v[180:183]
  buffer_load_dwordx4 v21, s[12:15], s44 offen offset:1024  lds
  v_mul_f32_e64 v153, s68, v153
  v_mfma_f32_16x16x32_bf16 v[180:183], a[228:231], a[204:207], v[180:183]
  v_mul_f32 v154, s68, v154
  v_mul_f32 v155, s68, v155
  v_mfma_f32_16x16x32_bf16 v[180:183], a[244:247], a[220:223], v[180:183]
  v_cvt_pk_bf16_f32 v152, v152, v153
  v_cvt_pk_bf16_f32 v153, v154, v155
  v_mfma_f32_16x16x32_bf16 v[184:187], a[168:171], a[108:111], v[184:187]
  ds_write_b64 v98, v[152:153] offset:5120
  v_mul_f32_e64 v156, s68, v156
  v_mfma_f32_16x16x32_bf16 v[184:187], a[184:187], a[124:127], v[184:187]
  buffer_load_dwordx4 v20, s[12:15], s44 offen offset:2048  lds
  v_mul_f32_e64 v157, s68, v157
  v_mfma_f32_16x16x32_bf16 v[184:187], a[232:235], a[204:207], v[184:187]
  v_mul_f32 v158, s68, v158
  v_mul_f32 v159, s68, v159
  v_mfma_f32_16x16x32_bf16 v[184:187], a[248:251], a[220:223], v[184:187]
  v_cvt_pk_bf16_f32 v156, v156, v157
  v_cvt_pk_bf16_f32 v157, v158, v159
  v_mfma_f32_16x16x32_bf16 v[188:191], a[172:175], a[108:111], v[188:191]
  buffer_load_dwordx4 v21, s[12:15], s44 offen offset:3072  lds
  v_mfma_f32_16x16x32_bf16 v[188:191], a[188:191], a[124:127], v[188:191]
  ds_write_b64 v98, v[156:157] offset:5632
  v_mfma_f32_16x16x32_bf16 v[188:191], a[236:239], a[204:207], v[188:191]
  v_mfma_f32_16x16x32_bf16 v[188:191], a[252:255], a[220:223], v[188:191]
  v_pk_mul_f32 v[160:161], v[160:161], s[68:69]
  v_pk_mul_f32 v[162:163], v[162:163], s[68:69]
  v_cvt_pk_bf16_f32 v160, v160, v161
  v_cvt_pk_bf16_f32 v161, v162, v163
  v_pk_mul_f32 v[164:165], v[164:165], s[68:69]
  v_pk_mul_f32 v[166:167], v[166:167], s[68:69]
  v_cvt_pk_bf16_f32 v164, v164, v165
  v_cvt_pk_bf16_f32 v165, v166, v167
  ds_write_b64 v98, v[160:161] offset:8192
  v_pk_mul_f32 v[168:169], v[168:169], s[68:69]
  v_pk_mul_f32 v[170:171], v[170:171], s[68:69]
  v_cvt_pk_bf16_f32 v168, v168, v169
  v_cvt_pk_bf16_f32 v169, v170, v171
  ds_write_b64 v98, v[164:165] offset:8704
  v_pk_mul_f32 v[172:173], v[172:173], s[68:69]
  v_pk_mul_f32 v[174:175], v[174:175], s[68:69]
  v_cvt_pk_bf16_f32 v172, v172, v173
  v_cvt_pk_bf16_f32 v173, v174, v175
  ds_write_b64 v98, v[168:169] offset:9216
  v_pk_mul_f32 v[176:177], v[176:177], s[68:69]
  v_pk_mul_f32 v[178:179], v[178:179], s[68:69]
  v_cvt_pk_bf16_f32 v176, v176, v177
  v_cvt_pk_bf16_f32 v177, v178, v179
  ds_write_b64 v98, v[172:173] offset:9728
  v_pk_mul_f32 v[180:181], v[180:181], s[68:69]
  v_pk_mul_f32 v[182:183], v[182:183], s[68:69]
  v_cvt_pk_bf16_f32 v180, v180, v181
  v_cvt_pk_bf16_f32 v181, v182, v183
  ds_write_b64 v98, v[176:177] offset:12288
  v_pk_mul_f32 v[184:185], v[184:185], s[68:69]
  v_pk_mul_f32 v[186:187], v[186:187], s[68:69]
  v_cvt_pk_bf16_f32 v184, v184, v185
  v_cvt_pk_bf16_f32 v185, v186, v187
  ds_write_b64 v98, v[180:181] offset:12800
  v_pk_mul_f32 v[188:189], v[188:189], s[68:69]
  v_pk_mul_f32 v[190:191], v[190:191], s[68:69]
  v_cvt_pk_bf16_f32 v188, v188, v189
  v_cvt_pk_bf16_f32 v189, v190, v191
  ds_write_b64 v98, v[184:185] offset:13312
  ds_write_b64 v98, v[188:189] offset:13824
  s_cmp_eq_u32 s101, 0
  s_waitcnt vmcnt(12) lgkmcnt(0)
  s_barrier
  s_cbranch_scc0 L_slow
  ds_read_b128 a[212:215], v99 offset:0
  ds_read_b128 a[32:35], v97 offset:0
  ds_read_b128 a[216:219], v99 offset:64
  ds_read_b128 a[36:39], v97 offset:1024
  ds_read_b128 a[220:223], v99 offset:128
  ds_read_b128 a[40:43], v97 offset:2048
  ds_read_b128 a[224:227], v99 offset:192
  ds_read_b128 a[44:47], v97 offset:3072
  ds_read_b128 a[48:51], v97 offset:4096
  ds_read_b128 a[52:55], v97 offset:5120
  ds_read_b128 a[56:59], v97 offset:6144
  ds_read_b128 a[60:63], v97 offset:7168
  v_mov_b32 v120, v77
  v_mov_b32 v121, v77
  v_mov_b32 v122, v77
  v_mov_b32 v123, v77
  v_mov_b32 v104, 0
  v_mov_b32 v105, 0
  v_mov_b32 v106, 0
  v_mov_b32 v107, 0
  v_mov_b32 v108, 0
  v_mov_b32 v109, 0
  v_mov_b32 v110, 0
  v_mov_b32 v111, 0
  v_mov_b32_e64 v92, 0
  v_mov_b32 v93, 0
  s_waitcnt lgkmcnt(10)
  v_mfma_f32_16x16x32_bf16 v[64:67], a[212:215], a[32:35], 0
  s_waitcnt lgkmcnt(8)
  ds_read_b128 a[64:67], v4 offset:0
  ds_read_b128 a[68:71], v5 offset:0
  v_mfma_f32_16x16x32_bf16 v[64:67], a[216:219], a[36:39], v[64:67]
  s_waitcnt lgkmcnt(8)
  ds_read_b128 a[72:75], v6 offset:0
  ds_read_b128 a[76:79], v7 offset:0
  v_mfma_f32_16x16x32_bf16 v[64:67], a[220:223], a[40:43], v[64:67]
  s_waitcnt lgkmcnt(8)
  ds_read_b128 a[92:95], v7 offset:4096
  ds_read_b128 a[88:91], v6 offset:4096
  v_mfma_f32_16x16x32_bf16 v[64:67], a[224:227], a[44:47], v[64:67]
  s_waitcnt lgkmcnt(9)
  ds_read_b128 a[84:87], v5 offset:4096
  ds_read_b128 a[80:83], v4 offset:4096
  v_mfma_f32_16x16x32_bf16 v[68:71], a[212:215], a[48:51], 0
  s_waitcnt lgkmcnt(10)
  ds_read_b128 a[0:3], v96 offset:0
  ds_read_b128 a[4:7], v96 offset:1024
  v_mfma_f32_16x16x32_bf16 v[68:71], a[216:219], a[52:55], v[68:71]
  s_waitcnt lgkmcnt(11)
  ds_read_b128 a[8:11], v96 offset:2048
  ds_read_b128 a[12:15], v96 offset:3072
  v_mfma_f32_16x16x32_bf16 v[68:71], a[220:223], a[56:59], v[68:71]
  s_waitcnt lgkmcnt(12)
  ds_read_b128 a[16:19], v96 offset:4096
  ds_read_b128 a[20:23], v96 offset:5120
  v_mfma_f32_16x16x32_bf16 v[68:71], a[224:227], a[60:63], v[68:71]
  s_waitcnt lgkmcnt(13)
  ds_read_b128 a[24:27], v96 offset:6144
  ds_read_b128 a[28:31], v96 offset:7168
  v_max3_f32 v64, v64, v65, v66
  v_max_f32_e64 v64, v64, v67
  v_sub_f32 v65, 0xc0a00000, v64
  v_sub_f32 v66, 0xc0a00000, v64
  v_sub_f32 v67, 0xc0a00000, v64
  v_sub_f32 v64, 0xc0a00000, v64
  s_nop 1
  v_mfma_f32_16x16x32_bf16 v[32:35], a[64:67], a[32:35], v[64:67]
  s_waitcnt lgkmcnt(14)
  ds_read_b64_tr_b16 a[128:129], v8 offset:32768
  ds_read_b64_tr_b16 a[130:131], v8 offset:36864
  v_mfma_f32_16x16x32_bf16 v[32:35], a[68:71], a[36:39], v[32:35]
  s_waitcnt lgkmcnt(15)
  ds_read_b64_tr_b16 a[132:133], v9 offset:32768
  ds_read_b64_tr_b16 a[134:135], v9 offset:36864
  v_mfma_f32_16x16x32_bf16 v[32:35], a[72:75], a[40:43], v[32:35]
  s_waitcnt lgkmcnt(15)
  ds_read_b64_tr_b16 a[136:137], v10 offset:32768
  ds_read_b64_tr_b16 a[138:139], v10 offset:36864
  ds_read_b64_tr_b16 a[140:141], v11 offset:32768
  v_mfma_f32_16x16x32_bf16 v[32:35], a[76:79], a[44:47], v[32:35]
  buffer_atomic_add v76, v26, s[32:35], 0 offen sc1
  v_max3_f32 v68, v68, v69, v70
  v_max_f32_e64 v68, v68, v71
  v_mfma_f32_16x16x32_bf16 v[36:39], a[92:95], a[44:47], v[64:67]
  s_waitcnt lgkmcnt(15)
  v_sub_f32 v69, 0xc0a00000, v68
  v_sub_f32 v70, 0xc0a00000, v68
  v_mfma_f32_16x16x32_bf16 v[36:39], a[88:91], a[40:43], v[36:39]
  s_sub_u32 s43, s43, s57
  v_sub_f32 v71, 0xc0a00000, v68
  v_sub_f32 v68, 0xc0a00000, v68
  v_mfma_f32_16x16x32_bf16 v[36:39], a[84:87], a[36:39], v[36:39]
  s_and_b32 s43, s43, s57
  ds_read_b64_tr_b16 a[142:143], v11 offset:36864
  ds_read_b64_tr_b16 a[144:145], v12 offset:32768
  v_mfma_f32_16x16x32_bf16 v[36:39], a[80:83], a[32:35], v[36:39]
  s_waitcnt lgkmcnt(11)
  s_add_u32 m0, s41, 49152
  v_exp_f32_e64 v32, v32
  v_mfma_f32_16x16x32_bf16 v[56:59], a[212:215], a[0:3], 0
  ds_read_b64_tr_b16 a[146:147], v12 offset:36864
  ds_read_b64_tr_b16 a[148:149], v13 offset:32768
  buffer_load_dwordx4 v16, s[8:11], s43 offen offset:0 nt lds
  v_mfma_f32_16x16x32_bf16 v[56:59], a[216:219], a[4:7], v[56:59]
  v_exp_f32_e64 v33, v33
  v_mfma_f32_16x16x32_bf16 v[56:59], a[220:223], a[8:11], v[56:59]
  ds_read_b64_tr_b16 a[150:151], v13 offset:36864
  v_cvt_pk_bf16_f32 v48, v32, v33
  v_mfma_f32_16x16x32_bf16 v[56:59], a[224:227], a[12:15], v[56:59]
  v_exp_f32_e64 v34, v34
  v_mfma_f32_16x16x32_bf16 v[60:63], a[212:215], a[16:19], 0
  ds_read_b64_tr_b16 a[152:153], v14 offset:32768
  ds_read_b64_tr_b16 a[154:155], v14 offset:36864
  ds_read_b64_tr_b16 a[156:157], v15 offset:32768
  v_mfma_f32_16x16x32_bf16 v[60:63], a[216:219], a[20:23], v[60:63]
  s_waitcnt lgkmcnt(8)
  v_exp_f32 v35, v35
  v_mfma_f32_16x16x32_bf16 v[60:63], a[220:223], a[24:27], v[60:63]
  ds_read_b64_tr_b16 a[158:159], v15 offset:36864
  buffer_load_dwordx4 v17, s[8:11], s43 offen offset:1024 nt lds
  v_cvt_pk_bf16_f32 v49, v34, v35
  v_mfma_f32_16x16x32_bf16 v[60:63], a[224:227], a[28:31], v[60:63]
  v_exp_f32_e64 v36, v36
  v_max3_f32 v56, v56, v57, v58
  v_max_f32_e64 v56, v56, v59
  v_mfma_f32_16x16x32_bf16 v[40:43], a[64:67], a[48:51], v[68:71]
  v_exp_f32_e64 v37, v37
  v_mfma_f32_16x16x32_bf16 v[40:43], a[68:71], a[52:55], v[40:43]
  v_cvt_pk_bf16_f32 v50, v36, v37
  v_sub_f32 v57, 0xc0a00000, v56
  v_mfma_f32_16x16x32_bf16 v[40:43], a[72:75], a[56:59], v[40:43]
  v_exp_f32_e64 v38, v38
  v_mfma_f32_16x16x32_bf16 v[40:43], a[76:79], a[60:63], v[40:43]
  v_sub_f32 v58, 0xc0a00000, v56
  v_sub_f32 v59, 0xc0a00000, v56
  v_mfma_f32_16x16x32_bf16 v[44:47], a[92:95], a[60:63], v[68:71]
  v_exp_f32_e64 v39, v39
  v_mfma_f32_16x16x32_bf16 v[44:47], a[88:91], a[56:59], v[44:47]
  buffer_load_dwordx4 v18, s[8:11], s43 offen offset:2048 nt lds
  v_cvt_pk_bf16_f32 v51, v38, v39
  v_sub_f32 v56, 0xc0a00000, v56
  v_mfma_f32_16x16x32_bf16 v[44:47], a[84:87], a[52:55], v[44:47]
  v_max3_f32 v60, v60, v61, v62
  v_max_f32_e64 v60, v60, v63
  v_mfma_f32_16x16x32_bf16 v[44:47], a[80:83], a[48:51], v[44:47]
  v_exp_f32_e64 v40, v40
  v_mfma_f32_16x16x32_bf16 v[192:195], a[128:131], v[48:51], 0
  v_sub_f32 v61, 0xc0a00000, v60
  v_sub_f32 v62, 0xc0a00000, v60
  v_mfma_f32_16x16x32_bf16 v[196:199], a[132:135], v[48:51], 0
  v_exp_f32_e64 v41, v41
  v_mfma_f32_16x16x32_bf16 v[200:203], a[136:139], v[48:51], 0
  s_waitcnt lgkmcnt(0)
  v_cvt_pk_bf16_f32 v52, v40, v41
  v_sub_f32 v63, 0xc0a00000, v60
  v_mfma_f32_16x16x32_bf16 v[204:207], a[140:143], v[48:51], 0
  v_exp_f32 v42, v42
  v_mfma_f32_16x16x32_bf16 v[208:211], a[144:147], v[48:51], 0
  buffer_load_dwordx4 v19, s[8:11], s43 offen offset:3072 nt lds
  v_sub_f32 v60, 0xc0a00000, v60
  v_mfma_f32_16x16x32_bf16 v[212:215], a[148:151], v[48:51], 0
  v_exp_f32_e64 v43, v43
  v_mfma_f32_16x16x32_bf16 v[216:219], a[152:155], v[48:51], 0
  s_add_u32 m0, s41, 81920
  v_cvt_pk_bf16_f32 v53, v42, v43
  v_mfma_f32_16x16x32_bf16 v[220:223], a[156:159], v[48:51], 0
  s_waitcnt vmcnt(13)
  v_exp_f32 v44, v44
  v_mfma_f32_16x16x32_bf16 v[32:35], a[64:67], a[0:3], v[56:59]
  s_barrier
  ds_read_b128 a[96:99], v4 offset:16384
  buffer_load_dwordx4 v20, s[12:15], s43 offen offset:0 nt lds
  v_mfma_f32_16x16x32_bf16 v[32:35], a[68:71], a[4:7], v[32:35]
  v_exp_f32 v45, v45
  v_mfma_f32_16x16x32_bf16 v[32:35], a[72:75], a[8:11], v[32:35]
  ds_read_b128 a[100:103], v5 offset:16384
  v_cvt_pk_bf16_f32 v54, v44, v45
  v_mfma_f32_16x16x32_bf16 v[32:35], a[76:79], a[12:15], v[32:35]
  v_exp_f32_e64 v46, v46
  v_mfma_f32_16x16x32_bf16 v[36:39], a[92:95], a[12:15], v[56:59]
  ds_read_b128 a[104:107], v6 offset:16384
  v_mfma_f32_16x16x32_bf16 v[36:39], a[88:91], a[8:11], v[36:39]
  v_exp_f32_e64 v47, v47
  v_mfma_f32_16x16x32_bf16 v[36:39], a[84:87], a[4:7], v[36:39]
  ds_read_b128 a[108:111], v7 offset:16384
  v_cvt_pk_bf16_f32 v55, v46, v47
  v_mfma_f32_16x16x32_bf16 v[36:39], a[80:83], a[0:3], v[36:39]
  v_exp_f32_e64 v32, v32
  v_smfmac_f32_16x16x64_bf16 v[108:111], v[120:123], v[48:55], v78
  ds_read_b128 a[124:127], v7 offset:20480
  buffer_load_dwordx4 v21, s[12:15], s43 offen offset:1024 nt lds
  v_mfma_f32_16x16x32_bf16 v[224:227], a[128:131], v[52:55], 0
  v_exp_f32_e64 v33, v33
  v_mfma_f32_16x16x32_bf16 v[228:231], a[132:135], v[52:55], 0
  ds_read_b128 a[120:123], v6 offset:20480
  v_cvt_pk_bf16_f32 v48, v32, v33
  v_mfma_f32_16x16x32_bf16 v[232:235], a[136:139], v[52:55], 0
  v_exp_f32_e64 v34, v34
  v_mfma_f32_16x16x32_bf16 v[236:239], a[140:143], v[52:55], 0
  ds_read_b128 a[116:119], v5 offset:20480
  v_mfma_f32_16x16x32_bf16 v[240:243], a[144:147], v[52:55], 0
  v_exp_f32_e64 v35, v35
  v_mfma_f32_16x16x32_bf16 v[244:247], a[148:151], v[52:55], 0
  ds_read_b128 a[112:115], v4 offset:20480
  v_cvt_pk_bf16_f32 v49, v34, v35
  v_mfma_f32_16x16x32_bf16 v[248:251], a[152:155], v[52:55], 0
  v_exp_f32_e64 v36, v36
  v_mfma_f32_16x16x32_bf16 v[252:255], a[156:159], v[52:55], 0
  ds_read_b64_tr_b16 a[160:161], v8 offset:49152
  buffer_load_dwordx4 v20, s[12:15], s43 offen offset:2048 nt lds
  v_mfma_f32_16x16x32_bf16 v[40:43], a[64:67], a[16:19], v[60:63]
  v_exp_f32_e64 v37, v37
  v_mfma_f32_16x16x32_bf16 v[40:43], a[68:71], a[20:23], v[40:43]
  ds_read_b64_tr_b16 a[162:163], v8 offset:53248
  v_cvt_pk_bf16_f32 v50, v36, v37
  v_mfma_f32_16x16x32_bf16 v[40:43], a[72:75], a[24:27], v[40:43]
  v_exp_f32_e64 v38, v38
  v_mfma_f32_16x16x32_bf16 v[40:43], a[76:79], a[28:31], v[40:43]
  ds_read_b64_tr_b16 a[164:165], v9 offset:49152
  buffer_load_dwordx4 v21, s[12:15], s43 offen offset:3072 nt lds
  v_mfma_f32_16x16x32_bf16 v[44:47], a[92:95], a[28:31], v[60:63]
  v_exp_f32_e64 v39, v39
  v_mfma_f32_16x16x32_bf16 v[44:47], a[88:91], a[24:27], v[44:47]
  ds_read_b64_tr_b16 a[166:167], v9 offset:53248
  v_cvt_pk_bf16_f32 v51, v38, v39
  v_mfma_f32_16x16x32_bf16 v[44:47], a[84:87], a[20:23], v[44:47]
  ds_read_b64_tr_b16 a[168:169], v10 offset:49152
  v_mfma_f32_16x16x32_bf16 v[44:47], a[80:83], a[16:19], v[44:47]
  v_exp_f32_e64 v40, v40
  v_mfma_f32_16x16x32_bf16 v[128:131], a[128:131], v[48:51], 0
  ds_read_b64_tr_b16 a[170:171], v10 offset:53248
  v_mfma_f32_16x16x32_bf16 v[132:135], a[132:135], v[48:51], 0
  v_exp_f32_e64 v41, v41
  v_mfma_f32_16x16x32_bf16 v[136:139], a[136:139], v[48:51], 0
  ds_read_b64_tr_b16 a[172:173], v11 offset:49152
  v_cvt_pk_bf16_f32 v52, v40, v41
  v_mfma_f32_16x16x32_bf16 v[140:143], a[140:143], v[48:51], 0
  v_exp_f32_e64 v42, v42
  v_mfma_f32_16x16x32_bf16 v[144:147], a[144:147], v[48:51], 0
  ds_read_b64_tr_b16 a[174:175], v11 offset:53248
  v_mfma_f32_16x16x32_bf16 v[148:151], a[148:151], v[48:51], 0
  v_exp_f32_e64 v43, v43
  v_mfma_f32_16x16x32_bf16 v[152:155], a[152:155], v[48:51], 0
  ds_read_b64_tr_b16 a[176:177], v12 offset:49152
  v_cvt_pk_bf16_f32 v53, v42, v43
  v_mfma_f32_16x16x32_bf16 v[156:159], a[156:159], v[48:51], 0
  s_waitcnt lgkmcnt(4)
  v_exp_f32 v44, v44
  v_mfma_f32_16x16x32_bf16 v[32:35], a[96:99], a[32:35], v[64:67]
  ds_read_b64_tr_b16 a[178:179], v12 offset:53248
  v_mfma_f32_16x16x32_bf16 v[32:35], a[100:103], a[36:39], v[32:35]
  v_exp_f32_e64 v45, v45
  v_mfma_f32_16x16x32_bf16 v[32:35], a[104:107], a[40:43], v[32:35]
  ds_read_b64_tr_b16 a[180:181], v13 offset:49152
  v_cvt_pk_bf16_f32 v54, v44, v45
  v_mfma_f32_16x16x32_bf16 v[32:35], a[108:111], a[44:47], v[32:35]
  s_sub_u32 s43, s43, s57
  v_exp_f32 v46, v46
  v_mfma_f32_16x16x32_bf16 v[36:39], a[124:127], a[44:47], v[64:67]
  ds_read_b64_tr_b16 a[182:183], v13 offset:53248
  v_mfma_f32_16x16x32_bf16 v[36:39], a[120:123], a[40:43], v[36:39]
  s_and_b32 s43, s43, s57
  v_exp_f32 v47, v47
  v_mfma_f32_16x16x32_bf16 v[36:39], a[116:119], a[36:39], v[36:39]
  ds_read_b64_tr_b16 a[184:185], v14 offset:49152
  v_cvt_pk_bf16_f32 v55, v46, v47
  v_mfma_f32_16x16x32_bf16 v[36:39], a[112:115], a[32:35], v[36:39]
  s_and_b32 m0, s41, 0xffff
  v_exp_f32_e64 v32, v32
  v_smfmac_f32_16x16x64_bf16 v[104:107], v[120:123], v[48:55], v78
  ds_read_b64_tr_b16 a[186:187], v14 offset:53248
  buffer_load_dwordx4 v16, s[8:11], s43 offen offset:0 nt lds
  v_mfma_f32_16x16x32_bf16 v[160:163], a[128:131], v[52:55], 0
  v_exp_f32_e64 v33, v33
  v_mfma_f32_16x16x32_bf16 v[164:167], a[132:135], v[52:55], 0
  ds_read_b64_tr_b16 a[188:189], v15 offset:49152
  v_cvt_pk_bf16_f32 v48, v32, v33
  v_mfma_f32_16x16x32_bf16 v[168:171], a[136:139], v[52:55], 0
  v_exp_f32_e64 v34, v34
  v_mfma_f32_16x16x32_bf16 v[172:175], a[140:143], v[52:55], 0
  ds_read_b64_tr_b16 a[190:191], v15 offset:53248
  v_mfma_f32_16x16x32_bf16 v[176:179], a[144:147], v[52:55], 0
  v_exp_f32_e64 v35, v35
  v_mfma_f32_16x16x32_bf16 v[180:183], a[148:151], v[52:55], 0
  v_cvt_pk_bf16_f32 v49, v34, v35
  v_mfma_f32_16x16x32_bf16 v[184:187], a[152:155], v[52:55], 0
  v_exp_f32_e64 v36, v36
  v_mfma_f32_16x16x32_bf16 v[188:191], a[156:159], v[52:55], 0
  buffer_load_dwordx4 v17, s[8:11], s43 offen offset:1024 nt lds
  v_mfma_f32_16x16x32_bf16 v[40:43], a[96:99], a[48:51], v[68:71]
  v_exp_f32_e64 v37, v37
  v_mfma_f32_16x16x32_bf16 v[40:43], a[100:103], a[52:55], v[40:43]
  v_cvt_pk_bf16_f32 v50, v36, v37
  v_mfma_f32_16x16x32_bf16 v[40:43], a[104:107], a[56:59], v[40:43]
  s_waitcnt vmcnt(11) lgkmcnt(0)
  v_exp_f32 v38, v38
  v_mfma_f32_16x16x32_bf16 v[40:43], a[108:111], a[60:63], v[40:43]
  s_barrier
  ds_read_b128 a[64:67], v4 offset:32768
  v_mfma_f32_16x16x32_bf16 v[44:47], a[124:127], a[60:63], v[68:71]
  v_exp_f32 v39, v39
  v_mfma_f32_16x16x32_bf16 v[44:47], a[120:123], a[56:59], v[44:47]
  ds_read_b128 a[68:71], v5 offset:32768
  v_cvt_pk_bf16_f32 v51, v38, v39
  v_mfma_f32_16x16x32_bf16 v[44:47], a[116:119], a[52:55], v[44:47]
  buffer_load_dwordx4 v18, s[8:11], s43 offen offset:2048 nt lds
  v_mfma_f32_16x16x32_bf16 v[44:47], a[112:115], a[48:51], v[44:47]
  v_exp_f32_e64 v40, v40
  v_mfma_f32_16x16x32_bf16 v[192:195], a[160:163], v[48:51], v[192:195]
  ds_read_b128 a[72:75], v6 offset:32768
  buffer_load_dwordx4 v19, s[8:11], s43 offen offset:3072 nt lds
  v_mfma_f32_16x16x32_bf16 v[196:199], a[164:167], v[48:51], v[196:199]
  v_exp_f32_e64 v41, v41
  v_mfma_f32_16x16x32_bf16 v[200:203], a[168:171], v[48:51], v[200:203]
  ds_read_b128 a[76:79], v7 offset:32768
  v_cvt_pk_bf16_f32 v52, v40, v41
  v_mfma_f32_16x16x32_bf16 v[204:207], a[172:175], v[48:51], v[204:207]
  v_exp_f32_e64 v42, v42
  v_mfma_f32_16x16x32_bf16 v[208:211], a[176:179], v[48:51], v[208:211]
  ds_read_b128 a[92:95], v7 offset:36864
  v_mfma_f32_16x16x32_bf16 v[212:215], a[180:183], v[48:51], v[212:215]
  v_exp_f32_e64 v43, v43
  v_mfma_f32_16x16x32_bf16 v[216:219], a[184:187], v[48:51], v[216:219]
  ds_read_b128 a[88:91], v6 offset:36864
  v_cvt_pk_bf16_f32 v53, v42, v43
  v_mfma_f32_16x16x32_bf16 v[220:223], a[188:191], v[48:51], v[220:223]
  s_add_u32 m0, s41, 98304
  v_exp_f32_e64 v44, v44
  v_mfma_f32_16x16x32_bf16 v[32:35], a[96:99], a[0:3], v[56:59]
  buffer_load_dwordx4 v20, s[12:15], s43 offen offset:0 nt lds
  v_mfma_f32_16x16x32_bf16 v[32:35], a[100:103], a[4:7], v[32:35]
  v_exp_f32_e64 v45, v45
  v_mfma_f32_16x16x32_bf16 v[32:35], a[104:107], a[8:11], v[32:35]
  ds_read_b128 a[84:87], v5 offset:36864
  v_cvt_pk_bf16_f32 v54, v44, v45
  v_mfma_f32_16x16x32_bf16 v[32:35], a[108:111], a[12:15], v[32:35]
  v_exp_f32_e64 v46, v46
  v_mfma_f32_16x16x32_bf16 v[36:39], a[124:127], a[12:15], v[56:59]
  ds_read_b128 a[80:83], v4 offset:36864
  v_mfma_f32_16x16x32_bf16 v[36:39], a[120:123], a[8:11], v[36:39]
  v_exp_f32_e64 v47, v47
  v_mfma_f32_16x16x32_bf16 v[36:39], a[116:119], a[4:7], v[36:39]
L_w1:
  s_cbranch_execz L_w5
  ds_read_b64_tr_b16 a[128:129], v8 offset:0
  v_cvt_pk_bf16_f32 v55, v46, v47
  v_mfma_f32_16x16x32_bf16 v[36:39], a[112:115], a[0:3], v[36:39]
  v_exp_f32 v32, v32
  v_smfmac_f32_16x16x64_bf16 v[108:111], v[120:123], v[48:55], v78
  ds_read_b64_tr_b16 a[130:131], v8 offset:4096
  buffer_load_dwordx4 v21, s[12:15], s43 offen offset:1024 nt lds
  v_mfma_f32_16x16x32_bf16 v[224:227], a[160:163], v[52:55], v[224:227]
  v_exp_f32_e64 v33, v33
  v_mfma_f32_16x16x32_bf16 v[228:231], a[164:167], v[52:55], v[228:231]
  v_cvt_pk_bf16_f32 v48, v32, v33
  v_mfma_f32_16x16x32_bf16 v[232:235], a[168:171], v[52:55], v[232:235]
  v_exp_f32_e64 v34, v34
  v_mfma_f32_16x16x32_bf16 v[236:239], a[172:175], v[52:55], v[236:239]
  ds_read_b64_tr_b16 a[132:133], v9 offset:0
  buffer_load_dwordx4 v20, s[12:15], s43 offen offset:2048 nt lds
  v_mfma_f32_16x16x32_bf16 v[240:243], a[176:179], v[52:55], v[240:243]
  v_exp_f32_e64 v35, v35
  v_mfma_f32_16x16x32_bf16 v[244:247], a[180:183], v[52:55], v[244:247]
  ds_read_b64_tr_b16 a[134:135], v9 offset:4096
  v_cvt_pk_bf16_f32 v49, v34, v35
  v_mfma_f32_16x16x32_bf16 v[248:251], a[184:187], v[52:55], v[248:251]
  v_exp_f32_e64 v36, v36
  v_mfma_f32_16x16x32_bf16 v[252:255], a[188:191], v[52:55], v[252:255]
  ds_read_b64_tr_b16 a[136:137], v10 offset:0
  v_mfma_f32_16x16x32_bf16 v[40:43], a[96:99], a[16:19], v[60:63]
  v_exp_f32_e64 v37, v37
  v_mfma_f32_16x16x32_bf16 v[40:43], a[100:103], a[20:23], v[40:43]
  v_cvt_pk_bf16_f32 v50, v36, v37
  v_mfma_f32_16x16x32_bf16 v[40:43], a[104:107], a[24:27], v[40:43]
  v_exp_f32_e64 v38, v38
  v_mfma_f32_16x16x32_bf16 v[40:43], a[108:111], a[28:31], v[40:43]
  ds_read_b64_tr_b16 a[138:139], v10 offset:4096
  v_mfma_f32_16x16x32_bf16 v[44:47], a[124:127], a[28:31], v[60:63]
  v_exp_f32_e64 v39, v39
  v_mfma_f32_16x16x32_bf16 v[44:47], a[120:123], a[24:27], v[44:47]
  ds_read_b64_tr_b16 a[140:141], v11 offset:0
  v_cvt_pk_bf16_f32 v51, v38, v39
  v_mfma_f32_16x16x32_bf16 v[44:47], a[116:119], a[20:23], v[44:47]
  buffer_load_dwordx4 v21, s[12:15], s43 offen offset:3072 nt lds
  v_mfma_f32_16x16x32_bf16 v[44:47], a[112:115], a[16:19], v[44:47]
  v_exp_f32_e64 v40, v40
  v_mfma_f32_16x16x32_bf16 v[128:131], a[160:163], v[48:51], v[128:131]
  ds_read_b64_tr_b16 a[142:143], v11 offset:4096
  v_mfma_f32_16x16x32_bf16 v[132:135], a[164:167], v[48:51], v[132:135]
  v_exp_f32_e64 v41, v41
  v_mfma_f32_16x16x32_bf16 v[136:139], a[168:171], v[48:51], v[136:139]
  ds_read_b64_tr_b16 a[144:145], v12 offset:0
  v_cvt_pk_bf16_f32 v52, v40, v41
  v_mfma_f32_16x16x32_bf16 v[140:143], a[172:175], v[48:51], v[140:143]
  v_exp_f32_e64 v42, v42
  v_mfma_f32_16x16x32_bf16 v[144:147], a[176:179], v[48:51], v[144:147]
  ds_read_b64_tr_b16 a[146:147], v12 offset:4096
  v_mfma_f32_16x16x32_bf16 v[148:151], a[180:183], v[48:51], v[148:151]
  v_exp_f32_e64 v43, v43
  v_mfma_f32_16x16x32_bf16 v[152:155], a[184:187], v[48:51], v[152:155]
  ds_read_b64_tr_b16 a[148:149], v13 offset:0
  v_cvt_pk_bf16_f32 v53, v42, v43
  v_mfma_f32_16x16x32_bf16 v[156:159], a[188:191], v[48:51], v[156:159]
  s_waitcnt lgkmcnt(4)
  v_exp_f32 v44, v44
  v_mfma_f32_16x16x32_bf16 v[32:35], a[64:67], a[32:35], v[64:67]
  v_mfma_f32_16x16x32_bf16 v[32:35], a[68:71], a[36:39], v[32:35]
  v_exp_f32_e64 v45, v45
  v_mfma_f32_16x16x32_bf16 v[32:35], a[72:75], a[40:43], v[32:35]
  v_cvt_pk_bf16_f32 v54, v44, v45
  ds_read_b64_tr_b16 a[150:151], v13 offset:4096
  v_mfma_f32_16x16x32_bf16 v[32:35], a[76:79], a[44:47], v[32:35]
  s_sub_u32 s43, s43, s57
  v_exp_f32 v46, v46
  v_mfma_f32_16x16x32_bf16 v[36:39], a[92:95], a[44:47], v[64:67]
  ds_read_b64_tr_b16 a[152:153], v14 offset:0
  v_mfma_f32_16x16x32_bf16 v[36:39], a[88:91], a[40:43], v[36:39]
  s_and_b32 s43, s43, s57
  v_exp_f32 v47, v47
  v_mfma_f32_16x16x32_bf16 v[36:39], a[84:87], a[36:39], v[36:39]
  v_cvt_pk_bf16_f32 v55, v46, v47
  ds_read_b64_tr_b16 a[154:155], v14 offset:4096
  v_mfma_f32_16x16x32_bf16 v[36:39], a[80:83], a[32:35], v[36:39]
  s_add_u32 m0, s41, 16384
  v_exp_f32_e64 v32, v32
  v_smfmac_f32_16x16x64_bf16 v[104:107], v[120:123], v[48:55], v78
  buffer_load_dwordx4 v16, s[8:11], s43 offen offset:0 nt lds
  ds_read_b64_tr_b16 a[156:157], v15 offset:0
  v_mfma_f32_16x16x32_bf16 v[160:163], a[160:163], v[52:55], v[160:163]
  v_exp_f32_e64 v33, v33
  v_mfma_f32_16x16x32_bf16 v[164:167], a[164:167], v[52:55], v[164:167]
  v_cvt_pk_bf16_f32 v48, v32, v33
  v_mfma_f32_16x16x32_bf16 v[168:171], a[168:171], v[52:55], v[168:171]
  v_exp_f32_e64 v34, v34
  v_mfma_f32_16x16x32_bf16 v[172:175], a[172:175], v[52:55], v[172:175]
  ds_read_b64_tr_b16 a[158:159], v15 offset:4096
  v_mfma_f32_16x16x32_bf16 v[176:179], a[176:179], v[52:55], v[176:179]
  v_exp_f32_e64 v35, v35
  v_mfma_f32_16x16x32_bf16 v[180:183], a[180:183], v[52:55], v[180:183]
  v_cvt_pk_bf16_f32 v49, v34, v35
  v_mfma_f32_16x16x32_bf16 v[184:187], a[184:187], v[52:55], v[184:187]
  v_exp_f32_e64 v36, v36
  v_mfma_f32_16x16x32_bf16 v[188:191], a[188:191], v[52:55], v[188:191]
  buffer_load_dwordx4 v17, s[8:11], s43 offen offset:1024 nt lds
  v_mfma_f32_16x16x32_bf16 v[40:43], a[64:67], a[48:51], v[68:71]
  v_exp_f32_e64 v37, v37
  v_mfma_f32_16x16x32_bf16 v[40:43], a[68:71], a[52:55], v[40:43]
  v_cvt_pk_bf16_f32 v50, v36, v37
  v_mfma_f32_16x16x32_bf16 v[40:43], a[72:75], a[56:59], v[40:43]
  s_waitcnt vmcnt(10) lgkmcnt(0)
  v_exp_f32 v38, v38
  v_mfma_f32_16x16x32_bf16 v[40:43], a[76:79], a[60:63], v[40:43]
  s_barrier
  ds_read_b128 a[96:99], v4 offset:49152
  v_mfma_f32_16x16x32_bf16 v[44:47], a[92:95], a[60:63], v[68:71]
  v_exp_f32 v39, v39
  v_mfma_f32_16x16x32_bf16 v[44:47], a[88:91], a[56:59], v[44:47]
  v_cvt_pk_bf16_f32 v51, v38, v39
  ds_read_b128 a[100:103], v5 offset:49152
  v_mfma_f32_16x16x32_bf16 v[44:47], a[84:87], a[52:55], v[44:47]
  buffer_load_dwordx4 v18, s[8:11], s43 offen offset:2048 nt lds
  v_mfma_f32_16x16x32_bf16 v[44:47], a[80:83], a[48:51], v[44:47]
  v_exp_f32_e64 v40, v40
  v_mfma_f32_16x16x32_bf16 v[192:195], a[128:131], v[48:51], v[192:195]
  buffer_load_dwordx4 v19, s[8:11], s43 offen offset:3072 nt lds
  ds_read_b128 a[104:107], v6 offset:49152
  v_mfma_f32_16x16x32_bf16 v[196:199], a[132:135], v[48:51], v[196:199]
  v_exp_f32_e64 v41, v41
  v_mfma_f32_16x16x32_bf16 v[200:203], a[136:139], v[48:51], v[200:203]
  v_cvt_pk_bf16_f32 v52, v40, v41
  ds_read_b128 a[108:111], v7 offset:49152
  v_mfma_f32_16x16x32_bf16 v[204:207], a[140:143], v[48:51], v[204:207]
  v_exp_f32_e64 v42, v42
  v_mfma_f32_16x16x32_bf16 v[208:211], a[144:147], v[48:51], v[208:211]
  ds_read_b128 a[124:127], v7 offset:53248
  v_mfma_f32_16x16x32_bf16 v[212:215], a[148:151], v[48:51], v[212:215]
  v_exp_f32_e64 v43, v43
  v_mfma_f32_16x16x32_bf16 v[216:219], a[152:155], v[48:51], v[216:219]
  v_cvt_pk_bf16_f32 v53, v42, v43
  ds_read_b128 a[120:123], v6 offset:53248
  v_mfma_f32_16x16x32_bf16 v[220:223], a[156:159], v[48:51], v[220:223]
  s_add_u32 m0, s41, 114688
  v_exp_f32_e64 v44, v44
  v_mfma_f32_16x16x32_bf16 v[32:35], a[64:67], a[0:3], v[56:59]
  buffer_load_dwordx4 v20, s[12:15], s43 offen offset:0 nt lds
  v_mfma_f32_16x16x32_bf16 v[32:35], a[68:71], a[4:7], v[32:35]
  v_exp_f32_e64 v45, v45
  v_mfma_f32_16x16x32_bf16 v[32:35], a[72:75], a[8:11], v[32:35]
  v_cvt_pk_bf16_f32 v54, v44, v45
  ds_read_b128 a[116:119], v5 offset:53248
  v_mfma_f32_16x16x32_bf16 v[32:35], a[76:79], a[12:15], v[32:35]
  v_exp_f32_e64 v46, v46
  v_mfma_f32_16x16x32_bf16 v[36:39], a[92:95], a[12:15], v[56:59]
  ds_read_b128 a[112:115], v4 offset:53248
  v_mfma_f32_16x16x32_bf16 v[36:39], a[88:91], a[8:11], v[36:39]
  v_exp_f32_e64 v47, v47
  v_mfma_f32_16x16x32_bf16 v[36:39], a[84:87], a[4:7], v[36:39]
  v_cvt_pk_bf16_f32 v55, v46, v47
  ds_read_b64_tr_b16 a[160:161], v8 offset:16384
  v_mfma_f32_16x16x32_bf16 v[36:39], a[80:83], a[0:3], v[36:39]
  v_exp_f32_e64 v32, v32
  v_smfmac_f32_16x16x64_bf16 v[108:111], v[120:123], v[48:55], v78
  buffer_load_dwordx4 v21, s[12:15], s43 offen offset:1024 nt lds
  ds_read_b64_tr_b16 a[162:163], v8 offset:20480
  v_mfma_f32_16x16x32_bf16 v[224:227], a[128:131], v[52:55], v[224:227]
  v_exp_f32_e64 v33, v33
  v_mfma_f32_16x16x32_bf16 v[228:231], a[132:135], v[52:55], v[228:231]
  v_cvt_pk_bf16_f32 v48, v32, v33
  v_mfma_f32_16x16x32_bf16 v[232:235], a[136:139], v[52:55], v[232:235]
  v_exp_f32_e64 v34, v34
  v_mfma_f32_16x16x32_bf16 v[236:239], a[140:143], v[52:55], v[236:239]
  buffer_load_dwordx4 v20, s[12:15], s43 offen offset:2048 nt lds
  ds_read_b64_tr_b16 a[164:165], v9 offset:16384
  v_mfma_f32_16x16x32_bf16 v[240:243], a[144:147], v[52:55], v[240:243]
  v_exp_f32_e64 v35, v35
  v_mfma_f32_16x16x32_bf16 v[244:247], a[148:151], v[52:55], v[244:247]
  v_cvt_pk_bf16_f32 v49, v34, v35
  ds_read_b64_tr_b16 a[166:167], v9 offset:20480
  v_mfma_f32_16x16x32_bf16 v[248:251], a[152:155], v[52:55], v[248:251]
  v_exp_f32_e64 v36, v36
  v_mfma_f32_16x16x32_bf16 v[252:255], a[156:159], v[52:55], v[252:255]
  ds_read_b64_tr_b16 a[168:169], v10 offset:16384
  v_mfma_f32_16x16x32_bf16 v[40:43], a[64:67], a[16:19], v[60:63]
  v_exp_f32_e64 v37, v37
  v_mfma_f32_16x16x32_bf16 v[40:43], a[68:71], a[20:23], v[40:43]
  v_cvt_pk_bf16_f32 v50, v36, v37
  v_mfma_f32_16x16x32_bf16 v[40:43], a[72:75], a[24:27], v[40:43]
  v_exp_f32_e64 v38, v38
  v_mfma_f32_16x16x32_bf16 v[40:43], a[76:79], a[28:31], v[40:43]
  ds_read_b64_tr_b16 a[170:171], v10 offset:20480
  v_mfma_f32_16x16x32_bf16 v[44:47], a[92:95], a[28:31], v[60:63]
  v_exp_f32_e64 v39, v39
  v_mfma_f32_16x16x32_bf16 v[44:47], a[88:91], a[24:27], v[44:47]
  v_cvt_pk_bf16_f32 v51, v38, v39
  ds_read_b64_tr_b16 a[172:173], v11 offset:16384
  v_mfma_f32_16x16x32_bf16 v[44:47], a[84:87], a[20:23], v[44:47]
  buffer_load_dwordx4 v21, s[12:15], s43 offen offset:3072 nt lds
  v_mfma_f32_16x16x32_bf16 v[44:47], a[80:83], a[16:19], v[44:47]
  v_exp_f32_e64 v40, v40
  v_mfma_f32_16x16x32_bf16 v[128:131], a[128:131], v[48:51], v[128:131]
  ds_read_b64_tr_b16 a[174:175], v11 offset:20480
  v_mfma_f32_16x16x32_bf16 v[132:135], a[132:135], v[48:51], v[132:135]
  v_exp_f32_e64 v41, v41
  v_mfma_f32_16x16x32_bf16 v[136:139], a[136:139], v[48:51], v[136:139]
  v_cvt_pk_bf16_f32 v52, v40, v41
  ds_read_b64_tr_b16 a[176:177], v12 offset:16384
  v_mfma_f32_16x16x32_bf16 v[140:143], a[140:143], v[48:51], v[140:143]
  v_exp_f32_e64 v42, v42
  v_mfma_f32_16x16x32_bf16 v[144:147], a[144:147], v[48:51], v[144:147]
  ds_read_b64_tr_b16 a[178:179], v12 offset:20480
  v_mfma_f32_16x16x32_bf16 v[148:151], a[148:151], v[48:51], v[148:151]
  v_exp_f32_e64 v43, v43
  v_mfma_f32_16x16x32_bf16 v[152:155], a[152:155], v[48:51], v[152:155]
  v_cvt_pk_bf16_f32 v53, v42, v43
  ds_read_b64_tr_b16 a[180:181], v13 offset:16384
  v_mfma_f32_16x16x32_bf16 v[156:159], a[156:159], v[48:51], v[156:159]
  s_waitcnt lgkmcnt(4)
  v_exp_f32 v44, v44
  v_mfma_f32_16x16x32_bf16 v[32:35], a[96:99], a[32:35], v[64:67]
  v_mfma_f32_16x16x32_bf16 v[32:35], a[100:103], a[36:39], v[32:35]
  v_exp_f32_e64 v45, v45
  v_mfma_f32_16x16x32_bf16 v[32:35], a[104:107], a[40:43], v[32:35]
  v_cvt_pk_bf16_f32 v54, v44, v45
  ds_read_b64_tr_b16 a[182:183], v13 offset:20480
  v_mfma_f32_16x16x32_bf16 v[32:35], a[108:111], a[44:47], v[32:35]
  s_sub_u32 s43, s43, s57
  v_exp_f32 v46, v46
  v_mfma_f32_16x16x32_bf16 v[36:39], a[124:127], a[44:47], v[64:67]
  ds_read_b64_tr_b16 a[184:185], v14 offset:16384
  v_mfma_f32_16x16x32_bf16 v[36:39], a[120:123], a[40:43], v[36:39]
  s_and_b32 s43, s43, s57
  v_exp_f32 v47, v47
  v_mfma_f32_16x16x32_bf16 v[36:39], a[116:119], a[36:39], v[36:39]
  v_cvt_pk_bf16_f32 v55, v46, v47
  ds_read_b64_tr_b16 a[186:187], v14 offset:20480
  v_mfma_f32_16x16x32_bf16 v[36:39], a[112:115], a[32:35], v[36:39]
  s_add_u32 m0, s41, 32768
  v_exp_f32_e64 v32, v32
  v_smfmac_f32_16x16x64_bf16 v[104:107], v[120:123], v[48:55], v78
  buffer_load_dwordx4 v16, s[8:11], s43 offen offset:0 nt lds
  ds_read_b64_tr_b16 a[188:189], v15 offset:16384
  v_mfma_f32_16x16x32_bf16 v[160:163], a[128:131], v[52:55], v[160:163]
  v_exp_f32_e64 v33, v33
  v_mfma_f32_16x16x32_bf16 v[164:167], a[132:135], v[52:55], v[164:167]
  v_cvt_pk_bf16_f32 v48, v32, v33
  v_mfma_f32_16x16x32_bf16 v[168:171], a[136:139], v[52:55], v[168:171]
  v_exp_f32_e64 v34, v34
  v_mfma_f32_16x16x32_bf16 v[172:175], a[140:143], v[52:55], v[172:175]
  ds_read_b64_tr_b16 a[190:191], v15 offset:20480
  v_mfma_f32_16x16x32_bf16 v[176:179], a[144:147], v[52:55], v[176:179]
  v_exp_f32_e64 v35, v35
  v_mfma_f32_16x16x32_bf16 v[180:183], a[148:151], v[52:55], v[180:183]
  v_cvt_pk_bf16_f32 v49, v34, v35
  v_mfma_f32_16x16x32_bf16 v[184:187], a[152:155], v[52:55], v[184:187]
  v_exp_f32_e64 v36, v36
  v_mfma_f32_16x16x32_bf16 v[188:191], a[156:159], v[52:55], v[188:191]
  buffer_load_dwordx4 v17, s[8:11], s43 offen offset:1024 nt lds
  v_mfma_f32_16x16x32_bf16 v[40:43], a[96:99], a[48:51], v[68:71]
  v_exp_f32_e64 v37, v37
  v_mfma_f32_16x16x32_bf16 v[40:43], a[100:103], a[52:55], v[40:43]
  v_cvt_pk_bf16_f32 v50, v36, v37
  v_mfma_f32_16x16x32_bf16 v[40:43], a[104:107], a[56:59], v[40:43]
  s_waitcnt vmcnt(10) lgkmcnt(0)
  v_exp_f32 v38, v38
  v_mfma_f32_16x16x32_bf16 v[40:43], a[108:111], a[60:63], v[40:43]
  s_barrier
  ds_read_b128 a[64:67], v4 offset:0
  v_mfma_f32_16x16x32_bf16 v[44:47], a[124:127], a[60:63], v[68:71]
  v_exp_f32 v39, v39
  v_mfma_f32_16x16x32_bf16 v[44:47], a[120:123], a[56:59], v[44:47]
  v_cvt_pk_bf16_f32 v51, v38, v39
  ds_read_b128 a[68:71], v5 offset:0
  v_mfma_f32_16x16x32_bf16 v[44:47], a[116:119], a[52:55], v[44:47]
  buffer_load_dwordx4 v18, s[8:11], s43 offen offset:2048 nt lds
  v_mfma_f32_16x16x32_bf16 v[44:47], a[112:115], a[48:51], v[44:47]
  v_exp_f32_e64 v40, v40
  v_mfma_f32_16x16x32_bf16 v[192:195], a[160:163], v[48:51], v[192:195]
  buffer_load_dwordx4 v19, s[8:11], s43 offen offset:3072 nt lds
  ds_read_b128 a[72:75], v6 offset:0
  v_mfma_f32_16x16x32_bf16 v[196:199], a[164:167], v[48:51], v[196:199]
  v_exp_f32_e64 v41, v41
  v_mfma_f32_16x16x32_bf16 v[200:203], a[168:171], v[48:51], v[200:203]
  v_cvt_pk_bf16_f32 v52, v40, v41
  ds_read_b128 a[76:79], v7 offset:0
  v_mfma_f32_16x16x32_bf16 v[204:207], a[172:175], v[48:51], v[204:207]
  v_exp_f32_e64 v42, v42
  v_mfma_f32_16x16x32_bf16 v[208:211], a[176:179], v[48:51], v[208:211]
  ds_read_b128 a[92:95], v7 offset:4096
  v_mfma_f32_16x16x32_bf16 v[212:215], a[180:183], v[48:51], v[212:215]
  v_exp_f32_e64 v43, v43
  v_mfma_f32_16x16x32_bf16 v[216:219], a[184:187], v[48:51], v[216:219]
  v_cvt_pk_bf16_f32 v53, v42, v43
  ds_read_b128 a[88:91], v6 offset:4096
  v_mfma_f32_16x16x32_bf16 v[220:223], a[188:191], v[48:51], v[220:223]
  s_add_u32 m0, s41, 65536
  v_exp_f32_e64 v44, v44
  v_mfma_f32_16x16x32_bf16 v[32:35], a[96:99], a[0:3], v[56:59]
  buffer_load_dwordx4 v20, s[12:15], s43 offen offset:0 nt lds
  v_mfma_f32_16x16x32_bf16 v[32:35], a[100:103], a[4:7], v[32:35]
  v_exp_f32_e64 v45, v45
  v_mfma_f32_16x16x32_bf16 v[32:35], a[104:107], a[8:11], v[32:35]
  v_cvt_pk_bf16_f32 v54, v44, v45
  ds_read_b128 a[84:87], v5 offset:4096
  v_mfma_f32_16x16x32_bf16 v[32:35], a[108:111], a[12:15], v[32:35]
  v_exp_f32_e64 v46, v46
  v_mfma_f32_16x16x32_bf16 v[36:39], a[124:127], a[12:15], v[56:59]
  ds_read_b128 a[80:83], v4 offset:4096
  v_mfma_f32_16x16x32_bf16 v[36:39], a[120:123], a[8:11], v[36:39]
  v_exp_f32_e64 v47, v47
  v_mfma_f32_16x16x32_bf16 v[36:39], a[116:119], a[4:7], v[36:39]
  v_cvt_pk_bf16_f32 v55, v46, v47
  ds_read_b64_tr_b16 a[128:129], v8 offset:32768
  v_mfma_f32_16x16x32_bf16 v[36:39], a[112:115], a[0:3], v[36:39]
  v_exp_f32_e64 v32, v32
  v_smfmac_f32_16x16x64_bf16 v[108:111], v[120:123], v[48:55], v78
  buffer_load_dwordx4 v21, s[12:15], s43 offen offset:1024 nt lds
  ds_read_b64_tr_b16 a[130:131], v8 offset:36864
  v_mfma_f32_16x16x32_bf16 v[224:227], a[160:163], v[52:55], v[224:227]
  v_exp_f32_e64 v33, v33
  v_mfma_f32_16x16x32_bf16 v[228:231], a[164:167], v[52:55], v[228:231]
  v_cvt_pk_bf16_f32 v48, v32, v33
  v_mfma_f32_16x16x32_bf16 v[232:235], a[168:171], v[52:55], v[232:235]
  v_exp_f32_e64 v34, v34
  v_mfma_f32_16x16x32_bf16 v[236:239], a[172:175], v[52:55], v[236:239]
  buffer_load_dwordx4 v20, s[12:15], s43 offen offset:2048 nt lds
  ds_read_b64_tr_b16 a[132:133], v9 offset:32768
  v_mfma_f32_16x16x32_bf16 v[240:243], a[176:179], v[52:55], v[240:243]
  v_exp_f32_e64 v35, v35
  v_mfma_f32_16x16x32_bf16 v[244:247], a[180:183], v[52:55], v[244:247]
  v_cvt_pk_bf16_f32 v49, v34, v35
  ds_read_b64_tr_b16 a[134:135], v9 offset:36864
  v_mfma_f32_16x16x32_bf16 v[248:251], a[184:187], v[52:55], v[248:251]
  v_exp_f32_e64 v36, v36
  v_mfma_f32_16x16x32_bf16 v[252:255], a[188:191], v[52:55], v[252:255]
  ds_read_b64_tr_b16 a[136:137], v10 offset:32768
  v_mfma_f32_16x16x32_bf16 v[40:43], a[96:99], a[16:19], v[60:63]
  v_exp_f32_e64 v37, v37
  v_mfma_f32_16x16x32_bf16 v[40:43], a[100:103], a[20:23], v[40:43]
  v_cvt_pk_bf16_f32 v50, v36, v37
  v_mfma_f32_16x16x32_bf16 v[40:43], a[104:107], a[24:27], v[40:43]
  v_exp_f32_e64 v38, v38
  v_mfma_f32_16x16x32_bf16 v[40:43], a[108:111], a[28:31], v[40:43]
  ds_read_b64_tr_b16 a[138:139], v10 offset:36864
  v_mfma_f32_16x16x32_bf16 v[44:47], a[124:127], a[28:31], v[60:63]
  v_exp_f32_e64 v39, v39
  v_mfma_f32_16x16x32_bf16 v[44:47], a[120:123], a[24:27], v[44:47]
  v_cvt_pk_bf16_f32 v51, v38, v39
  ds_read_b64_tr_b16 a[140:141], v11 offset:32768
  v_mfma_f32_16x16x32_bf16 v[44:47], a[116:119], a[20:23], v[44:47]
  buffer_load_dwordx4 v21, s[12:15], s43 offen offset:3072 nt lds
  v_mfma_f32_16x16x32_bf16 v[44:47], a[112:115], a[16:19], v[44:47]
  v_exp_f32_e64 v40, v40
  v_mfma_f32_16x16x32_bf16 v[128:131], a[160:163], v[48:51], v[128:131]
  ds_read_b64_tr_b16 a[142:143], v11 offset:36864
  v_mfma_f32_16x16x32_bf16 v[132:135], a[164:167], v[48:51], v[132:135]
  v_exp_f32_e64 v41, v41
  v_mfma_f32_16x16x32_bf16 v[136:139], a[168:171], v[48:51], v[136:139]
  ds_read_b64_tr_b16 a[144:145], v12 offset:32768
  v_cvt_pk_bf16_f32 v52, v40, v41
  v_mfma_f32_16x16x32_bf16 v[140:143], a[172:175], v[48:51], v[140:143]
  s_mov_b32 s48, -5
  v_exp_f32 v42, v42
  v_mfma_f32_16x16x32_bf16 v[144:147], a[176:179], v[48:51], v[144:147]
L_att:
  v_mfma_f32_16x16x32_bf16 v[148:151], a[180:183], v[48:51], v[148:151]
  v_exp_f32_e64 v43, v43
  v_mfma_f32_16x16x32_bf16 v[152:155], a[184:187], v[48:51], v[152:155]
  ds_read_b64_tr_b16 a[146:147], v12 offset:36864
  v_cvt_pk_bf16_f32 v53, v42, v43
  v_mfma_f32_16x16x32_bf16 v[156:159], a[188:191], v[48:51], v[156:159]
  s_waitcnt lgkmcnt(3)
  v_exp_f32 v44, v44
  v_mfma_f32_16x16x32_bf16 v[32:35], a[64:67], a[32:35], v[64:67]
  ds_read_b64_tr_b16 a[148:149], v13 offset:32768
  v_mfma_f32_16x16x32_bf16 v[32:35], a[68:71], a[36:39], v[32:35]
  v_exp_f32_e64 v45, v45
  v_mfma_f32_16x16x32_bf16 v[32:35], a[72:75], a[40:43], v[32:35]
  ds_read_b64_tr_b16 a[150:151], v13 offset:36864
  v_cvt_pk_bf16_f32 v54, v44, v45
  v_mfma_f32_16x16x32_bf16 v[32:35], a[76:79], a[44:47], v[32:35]
  s_sub_u32 s43, s43, s57
  v_exp_f32 v46, v46
  v_mfma_f32_16x16x32_bf16 v[36:39], a[92:95], a[44:47], v[64:67]
  ds_read_b64_tr_b16 a[152:153], v14 offset:32768
  v_mfma_f32_16x16x32_bf16 v[36:39], a[88:91], a[40:43], v[36:39]
  s_and_b32 s43, s43, s57
  v_exp_f32 v47, v47
  v_mfma_f32_16x16x32_bf16 v[36:39], a[84:87], a[36:39], v[36:39]
  ds_read_b64_tr_b16 a[154:155], v14 offset:36864
  v_cvt_pk_bf16_f32 v55, v46, v47
  v_mfma_f32_16x16x32_bf16 v[36:39], a[80:83], a[32:35], v[36:39]
  s_add_u32 m0, s41, 49152
  v_exp_f32_e64 v32, v32
  v_smfmac_f32_16x16x64_bf16 v[104:107], v[120:123], v[48:55], v78
  ds_read_b64_tr_b16 a[156:157], v15 offset:32768
  buffer_load_dwordx4 v16, s[8:11], s43 offen offset:0 nt lds
  v_mfma_f32_16x16x32_bf16 v[160:163], a[160:163], v[52:55], v[160:163]
  v_exp_f32_e64 v33, v33
  v_mfma_f32_16x16x32_bf16 v[164:167], a[164:167], v[52:55], v[164:167]
  v_cvt_pk_bf16_f32 v48, v32, v33
  v_mfma_f32_16x16x32_bf16 v[168:171], a[168:171], v[52:55], v[168:171]
  v_exp_f32_e64 v34, v34
  v_mfma_f32_16x16x32_bf16 v[172:175], a[172:175], v[52:55], v[172:175]
  ds_read_b64_tr_b16 a[158:159], v15 offset:36864
  v_mfma_f32_16x16x32_bf16 v[176:179], a[176:179], v[52:55], v[176:179]
  v_exp_f32_e64 v35, v35
  v_mfma_f32_16x16x32_bf16 v[180:183], a[180:183], v[52:55], v[180:183]
  v_cvt_pk_bf16_f32 v49, v34, v35
  v_mfma_f32_16x16x32_bf16 v[184:187], a[184:187], v[52:55], v[184:187]
  v_exp_f32_e64 v36, v36
  v_mfma_f32_16x16x32_bf16 v[188:191], a[188:191], v[52:55], v[188:191]
  buffer_load_dwordx4 v17, s[8:11], s43 offen offset:1024 nt lds
  v_mfma_f32_16x16x32_bf16 v[40:43], a[64:67], a[48:51], v[68:71]
  v_exp_f32_e64 v37, v37
  v_mfma_f32_16x16x32_bf16 v[40:43], a[68:71], a[52:55], v[40:43]
  v_cvt_pk_bf16_f32 v50, v36, v37
  v_mfma_f32_16x16x32_bf16 v[40:43], a[72:75], a[56:59], v[40:43]
  s_waitcnt vmcnt(10) lgkmcnt(0)
  v_exp_f32 v38, v38
  v_mfma_f32_16x16x32_bf16 v[40:43], a[76:79], a[60:63], v[40:43]
  s_barrier
  ds_read_b128 a[96:99], v4 offset:16384
  v_mfma_f32_16x16x32_bf16 v[44:47], a[92:95], a[60:63], v[68:71]
  v_exp_f32 v39, v39
  v_mfma_f32_16x16x32_bf16 v[44:47], a[88:91], a[56:59], v[44:47]
  ds_read_b128 a[100:103], v5 offset:16384
  v_cvt_pk_bf16_f32 v51, v38, v39
  v_mfma_f32_16x16x32_bf16 v[44:47], a[84:87], a[52:55], v[44:47]
  buffer_load_dwordx4 v18, s[8:11], s43 offen offset:2048 nt lds
  v_mfma_f32_16x16x32_bf16 v[44:47], a[80:83], a[48:51], v[44:47]
  v_exp_f32_e64 v40, v40
  v_mfma_f32_16x16x32_bf16 v[192:195], a[128:131], v[48:51], v[192:195]
  ds_read_b128 a[104:107], v6 offset:16384
  buffer_load_dwordx4 v19, s[8:11], s43 offen offset:3072 nt lds
  v_mfma_f32_16x16x32_bf16 v[196:199], a[132:135], v[48:51], v[196:199]
  v_exp_f32_e64 v41, v41
  v_mfma_f32_16x16x32_bf16 v[200:203], a[136:139], v[48:51], v[200:203]
  ds_read_b128 a[108:111], v7 offset:16384
  v_cvt_pk_bf16_f32 v52, v40, v41
  v_mfma_f32_16x16x32_bf16 v[204:207], a[140:143], v[48:51], v[204:207]
  v_exp_f32_e64 v42, v42
  v_mfma_f32_16x16x32_bf16 v[208:211], a[144:147], v[48:51], v[208:211]
  ds_read_b128 a[124:127], v7 offset:20480
  v_mfma_f32_16x16x32_bf16 v[212:215], a[148:151], v[48:51], v[212:215]
  v_exp_f32_e64 v43, v43
  v_mfma_f32_16x16x32_bf16 v[216:219], a[152:155], v[48:51], v[216:219]
  ds_read_b128 a[120:123], v6 offset:20480
  v_cvt_pk_bf16_f32 v53, v42, v43
  v_mfma_f32_16x16x32_bf16 v[220:223], a[156:159], v[48:51], v[220:223]
  s_add_u32 m0, s41, 81920
  v_exp_f32_e64 v44, v44
  v_mfma_f32_16x16x32_bf16 v[32:35], a[64:67], a[0:3], v[56:59]
  buffer_load_dwordx4 v20, s[12:15], s43 offen offset:0 nt lds
  v_mfma_f32_16x16x32_bf16 v[32:35], a[68:71], a[4:7], v[32:35]
  v_exp_f32_e64 v45, v45
  v_mfma_f32_16x16x32_bf16 v[32:35], a[72:75], a[8:11], v[32:35]
  ds_read_b128 a[116:119], v5 offset:20480
  v_cvt_pk_bf16_f32 v54, v44, v45
  v_mfma_f32_16x16x32_bf16 v[32:35], a[76:79], a[12:15], v[32:35]
  v_exp_f32_e64 v46, v46
  v_mfma_f32_16x16x32_bf16 v[36:39], a[92:95], a[12:15], v[56:59]
  ds_read_b128 a[112:115], v4 offset:20480
  v_mfma_f32_16x16x32_bf16 v[36:39], a[88:91], a[8:11], v[36:39]
  v_exp_f32_e64 v47, v47
  v_mfma_f32_16x16x32_bf16 v[36:39], a[84:87], a[4:7], v[36:39]
  ds_read_b64_tr_b16 a[160:161], v8 offset:49152
  v_cvt_pk_bf16_f32 v55, v46, v47
  v_mfma_f32_16x16x32_bf16 v[36:39], a[80:83], a[0:3], v[36:39]
  v_exp_f32_e64 v32, v32
  v_smfmac_f32_16x16x64_bf16 v[108:111], v[120:123], v[48:55], v78
  ds_read_b64_tr_b16 a[162:163], v8 offset:53248
  buffer_load_dwordx4 v21, s[12:15], s43 offen offset:1024 nt lds
  v_mfma_f32_16x16x32_bf16 v[224:227], a[128:131], v[52:55], v[224:227]
  v_exp_f32_e64 v33, v33
  v_mfma_f32_16x16x32_bf16 v[228:231], a[132:135], v[52:55], v[228:231]
  v_cvt_pk_bf16_f32 v48, v32, v33
  v_mfma_f32_16x16x32_bf16 v[232:235], a[136:139], v[52:55], v[232:235]
  v_exp_f32_e64 v34, v34
  v_mfma_f32_16x16x32_bf16 v[236:239], a[140:143], v[52:55], v[236:239]
  ds_read_b64_tr_b16 a[164:165], v9 offset:49152
  buffer_load_dwordx4 v20, s[12:15], s43 offen offset:2048 nt lds
  v_mfma_f32_16x16x32_bf16 v[240:243], a[144:147], v[52:55], v[240:243]
  v_exp_f32_e64 v35, v35
  v_mfma_f32_16x16x32_bf16 v[244:247], a[148:151], v[52:55], v[244:247]
  ds_read_b64_tr_b16 a[166:167], v9 offset:53248
  v_cvt_pk_bf16_f32 v49, v34, v35
  v_mfma_f32_16x16x32_bf16 v[248:251], a[152:155], v[52:55], v[248:251]
  v_exp_f32_e64 v36, v36
  v_mfma_f32_16x16x32_bf16 v[252:255], a[156:159], v[52:55], v[252:255]
  ds_read_b64_tr_b16 a[168:169], v10 offset:49152
  v_mfma_f32_16x16x32_bf16 v[40:43], a[64:67], a[16:19], v[60:63]
  v_exp_f32_e64 v37, v37
  v_mfma_f32_16x16x32_bf16 v[40:43], a[68:71], a[20:23], v[40:43]
  v_cvt_pk_bf16_f32 v50, v36, v37
  v_mfma_f32_16x16x32_bf16 v[40:43], a[72:75], a[24:27], v[40:43]
  v_exp_f32_e64 v38, v38
  v_mfma_f32_16x16x32_bf16 v[40:43], a[76:79], a[28:31], v[40:43]
  ds_read_b64_tr_b16 a[170:171], v10 offset:53248
  v_mfma_f32_16x16x32_bf16 v[44:47], a[92:95], a[28:31], v[60:63]
  v_exp_f32_e64 v39, v39
  v_mfma_f32_16x16x32_bf16 v[44:47], a[88:91], a[24:27], v[44:47]
  ds_read_b64_tr_b16 a[172:173], v11 offset:49152
  v_cvt_pk_bf16_f32 v51, v38, v39
  v_mfma_f32_16x16x32_bf16 v[44:47], a[84:87], a[20:23], v[44:47]
  buffer_load_dwordx4 v21, s[12:15], s43 offen offset:3072 nt lds
  v_mfma_f32_16x16x32_bf16 v[44:47], a[80:83], a[16:19], v[44:47]
  v_exp_f32_e64 v40, v40
  v_mfma_f32_16x16x32_bf16 v[128:131], a[128:131], v[48:51], v[128:131]
  ds_read_b64_tr_b16 a[174:175], v11 offset:53248
  v_mfma_f32_16x16x32_bf16 v[132:135], a[132:135], v[48:51], v[132:135]
  v_exp_f32_e64 v41, v41
  v_mfma_f32_16x16x32_bf16 v[136:139], a[136:139], v[48:51], v[136:139]
  ds_read_b64_tr_b16 a[176:177], v12 offset:49152
  v_cvt_pk_bf16_f32 v52, v40, v41
  v_mfma_f32_16x16x32_bf16 v[140:143], a[140:143], v[48:51], v[140:143]
  v_exp_f32_e64 v42, v42
  v_mfma_f32_16x16x32_bf16 v[144:147], a[144:147], v[48:51], v[144:147]
  ds_read_b64_tr_b16 a[178:179], v12 offset:53248
  v_mfma_f32_16x16x32_bf16 v[148:151], a[148:151], v[48:51], v[148:151]
  v_exp_f32_e64 v43, v43
  v_mfma_f32_16x16x32_bf16 v[152:155], a[152:155], v[48:51], v[152:155]
  ds_read_b64_tr_b16 a[180:181], v13 offset:49152
  v_cvt_pk_bf16_f32 v53, v42, v43
  v_mfma_f32_16x16x32_bf16 v[156:159], a[156:159], v[48:51], v[156:159]
  s_waitcnt lgkmcnt(4)
  v_exp_f32 v44, v44
  v_mfma_f32_16x16x32_bf16 v[32:35], a[96:99], a[32:35], v[64:67]
  v_mfma_f32_16x16x32_bf16 v[32:35], a[100:103], a[36:39], v[32:35]
  v_exp_f32_e64 v45, v45
  v_mfma_f32_16x16x32_bf16 v[32:35], a[104:107], a[40:43], v[32:35]
  ds_read_b64_tr_b16 a[182:183], v13 offset:53248
  v_cvt_pk_bf16_f32 v54, v44, v45
  v_mfma_f32_16x16x32_bf16 v[32:35], a[108:111], a[44:47], v[32:35]
  s_sub_u32 s43, s43, s57
  v_exp_f32 v46, v46
  v_mfma_f32_16x16x32_bf16 v[36:39], a[124:127], a[44:47], v[64:67]
L_w2:
  s_cbranch_execz L_w6
  ds_read_b64_tr_b16 a[184:185], v14 offset:49152
  v_mfma_f32_16x16x32_bf16 v[36:39], a[120:123], a[40:43], v[36:39]
  s_and_b32 s43, s43, s57
  v_exp_f32_e64 v47, v47
  v_mfma_f32_16x16x32_bf16 v[36:39], a[116:119], a[36:39], v[36:39]
  ds_read_b64_tr_b16 a[186:187], v14 offset:53248
  v_cvt_pk_bf16_f32 v55, v46, v47
  v_mfma_f32_16x16x32_bf16 v[36:39], a[112:115], a[32:35], v[36:39]
  s_and_b32 m0, s41, 0xffff
  v_exp_f32_e64 v32, v32
  v_smfmac_f32_16x16x64_bf16 v[104:107], v[120:123], v[48:55], v78
  ds_read_b64_tr_b16 a[188:189], v15 offset:49152
  buffer_load_dwordx4 v16, s[8:11], s43 offen offset:0 nt lds
  v_mfma_f32_16x16x32_bf16 v[160:163], a[128:131], v[52:55], v[160:163]
  v_exp_f32_e64 v33, v33
  v_mfma_f32_16x16x32_bf16 v[164:167], a[132:135], v[52:55], v[164:167]
  v_cvt_pk_bf16_f32 v48, v32, v33
  v_mfma_f32_16x16x32_bf16 v[168:171], a[136:139], v[52:55], v[168:171]
  v_exp_f32_e64 v34, v34
  v_mfma_f32_16x16x32_bf16 v[172:175], a[140:143], v[52:55], v[172:175]
  ds_read_b64_tr_b16 a[190:191], v15 offset:53248
  v_mfma_f32_16x16x32_bf16 v[176:179], a[144:147], v[52:55], v[176:179]
  v_exp_f32_e64 v35, v35
  v_mfma_f32_16x16x32_bf16 v[180:183], a[148:151], v[52:55], v[180:183]
  v_cvt_pk_bf16_f32 v49, v34, v35
  v_mfma_f32_16x16x32_bf16 v[184:187], a[152:155], v[52:55], v[184:187]
  v_exp_f32_e64 v36, v36
  v_mfma_f32_16x16x32_bf16 v[188:191], a[156:159], v[52:55], v[188:191]
  buffer_load_dwordx4 v17, s[8:11], s43 offen offset:1024 nt lds
  v_mfma_f32_16x16x32_bf16 v[40:43], a[96:99], a[48:51], v[68:71]
  v_exp_f32_e64 v37, v37
  v_mfma_f32_16x16x32_bf16 v[40:43], a[100:103], a[52:55], v[40:43]
  v_cvt_pk_bf16_f32 v50, v36, v37
  v_mfma_f32_16x16x32_bf16 v[40:43], a[104:107], a[56:59], v[40:43]
  s_waitcnt vmcnt(10) lgkmcnt(0)
  v_exp_f32 v38, v38
  v_mfma_f32_16x16x32_bf16 v[40:43], a[108:111], a[60:63], v[40:43]
  s_barrier
  ds_read_b128 a[64:67], v4 offset:32768
  v_mfma_f32_16x16x32_bf16 v[44:47], a[124:127], a[60:63], v[68:71]
  v_exp_f32 v39, v39
  v_mfma_f32_16x16x32_bf16 v[44:47], a[120:123], a[56:59], v[44:47]
  ds_read_b128 a[68:71], v5 offset:32768
  v_cvt_pk_bf16_f32 v51, v38, v39
  v_mfma_f32_16x16x32_bf16 v[44:47], a[116:119], a[52:55], v[44:47]
  buffer_load_dwordx4 v18, s[8:11], s43 offen offset:2048 nt lds
  v_mfma_f32_16x16x32_bf16 v[44:47], a[112:115], a[48:51], v[44:47]
  v_exp_f32_e64 v40, v40
  v_mfma_f32_16x16x32_bf16 v[192:195], a[160:163], v[48:51], v[192:195]
  ds_read_b128 a[72:75], v6 offset:32768
  buffer_load_dwordx4 v19, s[8:11], s43 offen offset:3072 nt lds
  v_mfma_f32_16x16x32_bf16 v[196:199], a[164:167], v[48:51], v[196:199]
  v_exp_f32_e64 v41, v41
  v_mfma_f32_16x16x32_bf16 v[200:203], a[168:171], v[48:51], v[200:203]
  ds_read_b128 a[76:79], v7 offset:32768
  v_cvt_pk_bf16_f32 v52, v40, v41
  v_mfma_f32_16x16x32_bf16 v[204:207], a[172:175], v[48:51], v[204:207]
  v_exp_f32_e64 v42, v42
  v_mfma_f32_16x16x32_bf16 v[208:211], a[176:179], v[48:51], v[208:211]
  ds_read_b128 a[92:95], v7 offset:36864
  v_mfma_f32_16x16x32_bf16 v[212:215], a[180:183], v[48:51], v[212:215]
  v_exp_f32_e64 v43, v43
  v_mfma_f32_16x16x32_bf16 v[216:219], a[184:187], v[48:51], v[216:219]
  ds_read_b128 a[88:91], v6 offset:36864
  v_cvt_pk_bf16_f32 v53, v42, v43
  v_mfma_f32_16x16x32_bf16 v[220:223], a[188:191], v[48:51], v[220:223]
  s_add_u32 m0, s41, 98304
  v_exp_f32_e64 v44, v44
  v_mfma_f32_16x16x32_bf16 v[32:35], a[96:99], a[0:3], v[56:59]
  buffer_load_dwordx4 v20, s[12:15], s43 offen offset:0 nt lds
  v_mfma_f32_16x16x32_bf16 v[32:35], a[100:103], a[4:7], v[32:35]
  v_exp_f32_e64 v45, v45
  v_mfma_f32_16x16x32_bf16 v[32:35], a[104:107], a[8:11], v[32:35]
  ds_read_b128 a[84:87], v5 offset:36864
  v_cvt_pk_bf16_f32 v54, v44, v45
  v_mfma_f32_16x16x32_bf16 v[32:35], a[108:111], a[12:15], v[32:35]
  v_exp_f32_e64 v46, v46
  v_mfma_f32_16x16x32_bf16 v[36:39], a[124:127], a[12:15], v[56:59]
  ds_read_b128 a[80:83], v4 offset:36864
  v_mfma_f32_16x16x32_bf16 v[36:39], a[120:123], a[8:11], v[36:39]
  v_exp_f32_e64 v47, v47
  v_mfma_f32_16x16x32_bf16 v[36:39], a[116:119], a[4:7], v[36:39]
  ds_read_b64_tr_b16 a[128:129], v8 offset:0
  v_cvt_pk_bf16_f32 v55, v46, v47
  v_mfma_f32_16x16x32_bf16 v[36:39], a[112:115], a[0:3], v[36:39]
  v_exp_f32_e64 v32, v32
  v_smfmac_f32_16x16x64_bf16 v[108:111], v[120:123], v[48:55], v78
  ds_read_b64_tr_b16 a[130:131], v8 offset:4096
  buffer_load_dwordx4 v21, s[12:15], s43 offen offset:1024 nt lds
  v_mfma_f32_16x16x32_bf16 v[224:227], a[160:163], v[52:55], v[224:227]
  v_exp_f32_e64 v33, v33
  v_mfma_f32_16x16x32_bf16 v[228:231], a[164:167], v[52:55], v[228:231]
  v_cvt_pk_bf16_f32 v48, v32, v33
  v_mfma_f32_16x16x32_bf16 v[232:235], a[168:171], v[52:55], v[232:235]
  v_exp_f32_e64 v34, v34
  v_mfma_f32_16x16x32_bf16 v[236:239], a[172:175], v[52:55], v[236:239]
  ds_read_b64_tr_b16 a[132:133], v9 offset:0
  buffer_load_dwordx4 v20, s[12:15], s43 offen offset:2048 nt lds
  v_mfma_f32_16x16x32_bf16 v[240:243], a[176:179], v[52:55], v[240:243]
  v_exp_f32_e64 v35, v35
  v_mfma_f32_16x16x32_bf16 v[244:247], a[180:183], v[52:55], v[244:247]
  ds_read_b64_tr_b16 a[134:135], v9 offset:4096
  v_cvt_pk_bf16_f32 v49, v34, v35
  v_mfma_f32_16x16x32_bf16 v[248:251], a[184:187], v[52:55], v[248:251]
  v_exp_f32_e64 v36, v36
  v_mfma_f32_16x16x32_bf16 v[252:255], a[188:191], v[52:55], v[252:255]
  ds_read_b64_tr_b16 a[136:137], v10 offset:0
  v_mfma_f32_16x16x32_bf16 v[40:43], a[96:99], a[16:19], v[60:63]
  v_exp_f32_e64 v37, v37
  v_mfma_f32_16x16x32_bf16 v[40:43], a[100:103], a[20:23], v[40:43]
  v_cvt_pk_bf16_f32 v50, v36, v37
  v_mfma_f32_16x16x32_bf16 v[40:43], a[104:107], a[24:27], v[40:43]
  v_exp_f32_e64 v38, v38
  v_mfma_f32_16x16x32_bf16 v[40:43], a[108:111], a[28:31], v[40:43]
  ds_read_b64_tr_b16 a[138:139], v10 offset:4096
  v_mfma_f32_16x16x32_bf16 v[44:47], a[124:127], a[28:31], v[60:63]
  v_exp_f32_e64 v39, v39
  v_mfma_f32_16x16x32_bf16 v[44:47], a[120:123], a[24:27], v[44:47]
  ds_read_b64_tr_b16 a[140:141], v11 offset:0
  v_cvt_pk_bf16_f32 v51, v38, v39
  v_mfma_f32_16x16x32_bf16 v[44:47], a[116:119], a[20:23], v[44:47]
  buffer_load_dwordx4 v21, s[12:15], s43 offen offset:3072 nt lds
  v_mfma_f32_16x16x32_bf16 v[44:47], a[112:115], a[16:19], v[44:47]
  v_exp_f32_e64 v40, v40
  v_mfma_f32_16x16x32_bf16 v[128:131], a[160:163], v[48:51], v[128:131]
  ds_read_b64_tr_b16 a[142:143], v11 offset:4096
  v_mfma_f32_16x16x32_bf16 v[132:135], a[164:167], v[48:51], v[132:135]
  v_exp_f32_e64 v41, v41
  v_mfma_f32_16x16x32_bf16 v[136:139], a[168:171], v[48:51], v[136:139]
  ds_read_b64_tr_b16 a[144:145], v12 offset:0
  v_cvt_pk_bf16_f32 v52, v40, v41
  v_mfma_f32_16x16x32_bf16 v[140:143], a[172:175], v[48:51], v[140:143]
  v_exp_f32_e64 v42, v42
  v_mfma_f32_16x16x32_bf16 v[144:147], a[176:179], v[48:51], v[144:147]
  ds_read_b64_tr_b16 a[146:147], v12 offset:4096
  v_mfma_f32_16x16x32_bf16 v[148:151], a[180:183], v[48:51], v[148:151]
  v_exp_f32_e64 v43, v43
  v_mfma_f32_16x16x32_bf16 v[152:155], a[184:187], v[48:51], v[152:155]
  ds_read_b64_tr_b16 a[148:149], v13 offset:0
  v_cvt_pk_bf16_f32 v53, v42, v43
  v_mfma_f32_16x16x32_bf16 v[156:159], a[188:191], v[48:51], v[156:159]
  s_waitcnt lgkmcnt(4)
  v_exp_f32 v44, v44
  v_mfma_f32_16x16x32_bf16 v[32:35], a[64:67], a[32:35], v[64:67]
  v_mfma_f32_16x16x32_bf16 v[32:35], a[68:71], a[36:39], v[32:35]
  v_exp_f32_e64 v45, v45
  v_mfma_f32_16x16x32_bf16 v[32:35], a[72:75], a[40:43], v[32:35]
  ds_read_b64_tr_b16 a[150:151], v13 offset:4096
  v_cvt_pk_bf16_f32 v54, v44, v45
  v_mfma_f32_16x16x32_bf16 v[32:35], a[76:79], a[44:47], v[32:35]
  s_sub_u32 s43, s43, s57
  v_exp_f32 v46, v46
  v_mfma_f32_16x16x32_bf16 v[36:39], a[92:95], a[44:47], v[64:67]
  ds_read_b64_tr_b16 a[152:153], v14 offset:0
  v_mfma_f32_16x16x32_bf16 v[36:39], a[88:91], a[40:43], v[36:39]
  s_and_b32 s43, s43, s57
  v_exp_f32 v47, v47
  v_mfma_f32_16x16x32_bf16 v[36:39], a[84:87], a[36:39], v[36:39]
  ds_read_b64_tr_b16 a[154:155], v14 offset:4096
  v_cvt_pk_bf16_f32 v55, v46, v47
  v_mfma_f32_16x16x32_bf16 v[36:39], a[80:83], a[32:35], v[36:39]
  s_add_u32 m0, s41, 16384
  v_exp_f32_e64 v32, v32
  v_smfmac_f32_16x16x64_bf16 v[104:107], v[120:123], v[48:55], v78
  ds_read_b64_tr_b16 a[156:157], v15 offset:0
  buffer_load_dwordx4 v16, s[8:11], s43 offen offset:0 nt lds
  v_mfma_f32_16x16x32_bf16 v[160:163], a[160:163], v[52:55], v[160:163]
  v_exp_f32_e64 v33, v33
  v_mfma_f32_16x16x32_bf16 v[164:167], a[164:167], v[52:55], v[164:167]
  v_cvt_pk_bf16_f32 v48, v32, v33
  v_mfma_f32_16x16x32_bf16 v[168:171], a[168:171], v[52:55], v[168:171]
  v_exp_f32_e64 v34, v34
  v_mfma_f32_16x16x32_bf16 v[172:175], a[172:175], v[52:55], v[172:175]
  ds_read_b64_tr_b16 a[158:159], v15 offset:4096
  v_mfma_f32_16x16x32_bf16 v[176:179], a[176:179], v[52:55], v[176:179]
  v_exp_f32_e64 v35, v35
  v_mfma_f32_16x16x32_bf16 v[180:183], a[180:183], v[52:55], v[180:183]
  v_cvt_pk_bf16_f32 v49, v34, v35
  v_mfma_f32_16x16x32_bf16 v[184:187], a[184:187], v[52:55], v[184:187]
  v_exp_f32_e64 v36, v36
  v_mfma_f32_16x16x32_bf16 v[188:191], a[188:191], v[52:55], v[188:191]
  buffer_load_dwordx4 v17, s[8:11], s43 offen offset:1024 nt lds
  v_mfma_f32_16x16x32_bf16 v[40:43], a[64:67], a[48:51], v[68:71]
  v_exp_f32_e64 v37, v37
  v_mfma_f32_16x16x32_bf16 v[40:43], a[68:71], a[52:55], v[40:43]
  v_cvt_pk_bf16_f32 v50, v36, v37
  v_mfma_f32_16x16x32_bf16 v[40:43], a[72:75], a[56:59], v[40:43]
  s_waitcnt vmcnt(10) lgkmcnt(0)
  v_exp_f32 v38, v38
  v_mfma_f32_16x16x32_bf16 v[40:43], a[76:79], a[60:63], v[40:43]
  s_barrier
  ds_read_b128 a[96:99], v4 offset:49152
  v_mfma_f32_16x16x32_bf16 v[44:47], a[92:95], a[60:63], v[68:71]
  v_exp_f32 v39, v39
  v_mfma_f32_16x16x32_bf16 v[44:47], a[88:91], a[56:59], v[44:47]
  ds_read_b128 a[100:103], v5 offset:49152
  v_cvt_pk_bf16_f32 v51, v38, v39
  v_mfma_f32_16x16x32_bf16 v[44:47], a[84:87], a[52:55], v[44:47]
  buffer_load_dwordx4 v18, s[8:11], s43 offen offset:2048 nt lds
  v_mfma_f32_16x16x32_bf16 v[44:47], a[80:83], a[48:51], v[44:47]
  v_exp_f32_e64 v40, v40
  v_mfma_f32_16x16x32_bf16 v[192:195], a[128:131], v[48:51], v[192:195]
  ds_read_b128 a[104:107], v6 offset:49152
  buffer_load_dwordx4 v19, s[8:11], s43 offen offset:3072 nt lds
  v_mfma_f32_16x16x32_bf16 v[196:199], a[132:135], v[48:51], v[196:199]
  v_exp_f32_e64 v41, v41
  v_mfma_f32_16x16x32_bf16 v[200:203], a[136:139], v[48:51], v[200:203]
  ds_read_b128 a[108:111], v7 offset:49152
  v_cvt_pk_bf16_f32 v52, v40, v41
  v_mfma_f32_16x16x32_bf16 v[204:207], a[140:143], v[48:51], v[204:207]
  v_exp_f32_e64 v42, v42
  v_mfma_f32_16x16x32_bf16 v[208:211], a[144:147], v[48:51], v[208:211]
  ds_read_b128 a[124:127], v7 offset:53248
  v_mfma_f32_16x16x32_bf16 v[212:215], a[148:151], v[48:51], v[212:215]
  v_exp_f32_e64 v43, v43
  v_mfma_f32_16x16x32_bf16 v[216:219], a[152:155], v[48:51], v[216:219]
  ds_read_b128 a[120:123], v6 offset:53248
  v_cvt_pk_bf16_f32 v53, v42, v43
  v_mfma_f32_16x16x32_bf16 v[220:223], a[156:159], v[48:51], v[220:223]
  s_add_u32 m0, s41, 114688
  v_exp_f32_e64 v44, v44
  v_mfma_f32_16x16x32_bf16 v[32:35], a[64:67], a[0:3], v[56:59]
  buffer_load_dwordx4 v20, s[12:15], s43 offen offset:0 nt lds
  v_mfma_f32_16x16x32_bf16 v[32:35], a[68:71], a[4:7], v[32:35]
  v_exp_f32_e64 v45, v45
  v_mfma_f32_16x16x32_bf16 v[32:35], a[72:75], a[8:11], v[32:35]
  ds_read_b128 a[116:119], v5 offset:53248
  v_cvt_pk_bf16_f32 v54, v44, v45
  v_mfma_f32_16x16x32_bf16 v[32:35], a[76:79], a[12:15], v[32:35]
  v_exp_f32_e64 v46, v46
  v_mfma_f32_16x16x32_bf16 v[36:39], a[92:95], a[12:15], v[56:59]
  ds_read_b128 a[112:115], v4 offset:53248
  v_mfma_f32_16x16x32_bf16 v[36:39], a[88:91], a[8:11], v[36:39]
  v_exp_f32_e64 v47, v47
  v_mfma_f32_16x16x32_bf16 v[36:39], a[84:87], a[4:7], v[36:39]
  ds_read_b64_tr_b16 a[160:161], v8 offset:16384
  v_cvt_pk_bf16_f32 v55, v46, v47
  v_mfma_f32_16x16x32_bf16 v[36:39], a[80:83], a[0:3], v[36:39]
  v_exp_f32_e64 v32, v32
  v_smfmac_f32_16x16x64_bf16 v[108:111], v[120:123], v[48:55], v78
  ds_read_b64_tr_b16 a[162:163], v8 offset:20480
  buffer_load_dwordx4 v21, s[12:15], s43 offen offset:1024 nt lds
  v_mfma_f32_16x16x32_bf16 v[224:227], a[128:131], v[52:55], v[224:227]
  v_exp_f32_e64 v33, v33
  v_mfma_f32_16x16x32_bf16 v[228:231], a[132:135], v[52:55], v[228:231]
  v_cvt_pk_bf16_f32 v48, v32, v33
  v_mfma_f32_16x16x32_bf16 v[232:235], a[136:139], v[52:55], v[232:235]
  v_exp_f32_e64 v34, v34
  v_mfma_f32_16x16x32_bf16 v[236:239], a[140:143], v[52:55], v[236:239]
  ds_read_b64_tr_b16 a[164:165], v9 offset:16384
  buffer_load_dwordx4 v20, s[12:15], s43 offen offset:2048 nt lds
  v_mfma_f32_16x16x32_bf16 v[240:243], a[144:147], v[52:55], v[240:243]
  v_exp_f32_e64 v35, v35
  v_mfma_f32_16x16x32_bf16 v[244:247], a[148:151], v[52:55], v[244:247]
  ds_read_b64_tr_b16 a[166:167], v9 offset:20480
  v_cvt_pk_bf16_f32 v49, v34, v35
  v_mfma_f32_16x16x32_bf16 v[248:251], a[152:155], v[52:55], v[248:251]
  v_exp_f32_e64 v36, v36
  v_mfma_f32_16x16x32_bf16 v[252:255], a[156:159], v[52:55], v[252:255]
  ds_read_b64_tr_b16 a[168:169], v10 offset:16384
  v_mfma_f32_16x16x32_bf16 v[40:43], a[64:67], a[16:19], v[60:63]
  v_exp_f32_e64 v37, v37
  v_mfma_f32_16x16x32_bf16 v[40:43], a[68:71], a[20:23], v[40:43]
  v_cvt_pk_bf16_f32 v50, v36, v37
  v_mfma_f32_16x16x32_bf16 v[40:43], a[72:75], a[24:27], v[40:43]
  v_exp_f32_e64 v38, v38
  v_mfma_f32_16x16x32_bf16 v[40:43], a[76:79], a[28:31], v[40:43]
  ds_read_b64_tr_b16 a[170:171], v10 offset:20480
  v_mfma_f32_16x16x32_bf16 v[44:47], a[92:95], a[28:31], v[60:63]
  v_exp_f32_e64 v39, v39
  v_mfma_f32_16x16x32_bf16 v[44:47], a[88:91], a[24:27], v[44:47]
  ds_read_b64_tr_b16 a[172:173], v11 offset:16384
  v_cvt_pk_bf16_f32 v51, v38, v39
  v_mfma_f32_16x16x32_bf16 v[44:47], a[84:87], a[20:23], v[44:47]
  buffer_load_dwordx4 v21, s[12:15], s43 offen offset:3072 nt lds
  v_mfma_f32_16x16x32_bf16 v[44:47], a[80:83], a[16:19], v[44:47]
  v_exp_f32_e64 v40, v40
  v_mfma_f32_16x16x32_bf16 v[128:131], a[128:131], v[48:51], v[128:131]
  ds_read_b64_tr_b16 a[174:175], v11 offset:20480
  v_mfma_f32_16x16x32_bf16 v[132:135], a[132:135], v[48:51], v[132:135]
  v_exp_f32_e64 v41, v41
  v_mfma_f32_16x16x32_bf16 v[136:139], a[136:139], v[48:51], v[136:139]
  ds_read_b64_tr_b16 a[176:177], v12 offset:16384
  v_cvt_pk_bf16_f32 v52, v40, v41
  v_mfma_f32_16x16x32_bf16 v[140:143], a[140:143], v[48:51], v[140:143]
  v_exp_f32_e64 v42, v42
  v_mfma_f32_16x16x32_bf16 v[144:147], a[144:147], v[48:51], v[144:147]
  ds_read_b64_tr_b16 a[178:179], v12 offset:20480
  v_mfma_f32_16x16x32_bf16 v[148:151], a[148:151], v[48:51], v[148:151]
  v_exp_f32_e64 v43, v43
  v_mfma_f32_16x16x32_bf16 v[152:155], a[152:155], v[48:51], v[152:155]
  ds_read_b64_tr_b16 a[180:181], v13 offset:16384
  v_cvt_pk_bf16_f32 v53, v42, v43
  v_mfma_f32_16x16x32_bf16 v[156:159], a[156:159], v[48:51], v[156:159]
  s_waitcnt lgkmcnt(4)
  v_exp_f32 v44, v44
  v_mfma_f32_16x16x32_bf16 v[32:35], a[96:99], a[32:35], v[64:67]
  v_mfma_f32_16x16x32_bf16 v[32:35], a[100:103], a[36:39], v[32:35]
  v_exp_f32_e64 v45, v45
  v_mfma_f32_16x16x32_bf16 v[32:35], a[104:107], a[40:43], v[32:35]
  ds_read_b64_tr_b16 a[182:183], v13 offset:20480
  v_cvt_pk_bf16_f32 v54, v44, v45
  v_mfma_f32_16x16x32_bf16 v[32:35], a[108:111], a[44:47], v[32:35]
  s_sub_u32 s43, s43, s57
  v_exp_f32 v46, v46
  v_mfma_f32_16x16x32_bf16 v[36:39], a[124:127], a[44:47], v[64:67]
  ds_read_b64_tr_b16 a[184:185], v14 offset:16384
  v_mfma_f32_16x16x32_bf16 v[36:39], a[120:123], a[40:43], v[36:39]
  s_and_b32 s43, s43, s57
  v_exp_f32 v47, v47
  v_mfma_f32_16x16x32_bf16 v[36:39], a[116:119], a[36:39], v[36:39]
  ds_read_b64_tr_b16 a[186:187], v14 offset:20480
  v_cvt_pk_bf16_f32 v55, v46, v47
  v_mfma_f32_16x16x32_bf16 v[36:39], a[112:115], a[32:35], v[36:39]
  s_add_u32 m0, s41, 32768
  v_exp_f32_e64 v32, v32
  v_smfmac_f32_16x16x64_bf16 v[104:107], v[120:123], v[48:55], v78
  ds_read_b64_tr_b16 a[188:189], v15 offset:16384
  buffer_load_dwordx4 v16, s[8:11], s43 offen offset:0 nt lds
  v_mfma_f32_16x16x32_bf16 v[160:163], a[128:131], v[52:55], v[160:163]
  v_exp_f32_e64 v33, v33
  v_mfma_f32_16x16x32_bf16 v[164:167], a[132:135], v[52:55], v[164:167]
  v_cvt_pk_bf16_f32 v48, v32, v33
  v_mfma_f32_16x16x32_bf16 v[168:171], a[136:139], v[52:55], v[168:171]
  v_exp_f32_e64 v34, v34
  v_mfma_f32_16x16x32_bf16 v[172:175], a[140:143], v[52:55], v[172:175]
  ds_read_b64_tr_b16 a[190:191], v15 offset:20480
  v_mfma_f32_16x16x32_bf16 v[176:179], a[144:147], v[52:55], v[176:179]
  v_exp_f32_e64 v35, v35
  v_mfma_f32_16x16x32_bf16 v[180:183], a[148:151], v[52:55], v[180:183]
  v_cvt_pk_bf16_f32 v49, v34, v35
  v_mfma_f32_16x16x32_bf16 v[184:187], a[152:155], v[52:55], v[184:187]
  v_exp_f32_e64 v36, v36
  v_mfma_f32_16x16x32_bf16 v[188:191], a[156:159], v[52:55], v[188:191]
  buffer_load_dwordx4 v17, s[8:11], s43 offen offset:1024 nt lds
  v_mfma_f32_16x16x32_bf16 v[40:43], a[96:99], a[48:51], v[68:71]
  v_exp_f32_e64 v37, v37
  v_mfma_f32_16x16x32_bf16 v[40:43], a[100:103], a[52:55], v[40:43]
  v_cvt_pk_bf16_f32 v50, v36, v37
  v_mfma_f32_16x16x32_bf16 v[40:43], a[104:107], a[56:59], v[40:43]
  s_waitcnt vmcnt(10) lgkmcnt(0)
  v_exp_f32 v38, v38
  v_mfma_f32_16x16x32_bf16 v[40:43], a[108:111], a[60:63], v[40:43]
  s_barrier
  ds_read_b128 a[64:67], v4 offset:0
  v_mfma_f32_16x16x32_bf16 v[44:47], a[124:127], a[60:63], v[68:71]
  v_exp_f32 v39, v39
  v_mfma_f32_16x16x32_bf16 v[44:47], a[120:123], a[56:59], v[44:47]
  ds_read_b128 a[68:71], v5 offset:0
  v_cvt_pk_bf16_f32 v51, v38, v39
  v_mfma_f32_16x16x32_bf16 v[44:47], a[116:119], a[52:55], v[44:47]
  buffer_load_dwordx4 v18, s[8:11], s43 offen offset:2048 nt lds
  v_mfma_f32_16x16x32_bf16 v[44:47], a[112:115], a[48:51], v[44:47]
  v_exp_f32_e64 v40, v40
  v_mfma_f32_16x16x32_bf16 v[192:195], a[160:163], v[48:51], v[192:195]
  ds_read_b128 a[72:75], v6 offset:0
  buffer_load_dwordx4 v19, s[8:11], s43 offen offset:3072 nt lds
  v_mfma_f32_16x16x32_bf16 v[196:199], a[164:167], v[48:51], v[196:199]
  v_exp_f32_e64 v41, v41
  v_mfma_f32_16x16x32_bf16 v[200:203], a[168:171], v[48:51], v[200:203]
  ds_read_b128 a[76:79], v7 offset:0
  v_cvt_pk_bf16_f32 v52, v40, v41
  v_mfma_f32_16x16x32_bf16 v[204:207], a[172:175], v[48:51], v[204:207]
  v_exp_f32_e64 v42, v42
  v_mfma_f32_16x16x32_bf16 v[208:211], a[176:179], v[48:51], v[208:211]
  ds_read_b128 a[92:95], v7 offset:4096
  v_mfma_f32_16x16x32_bf16 v[212:215], a[180:183], v[48:51], v[212:215]
  v_exp_f32_e64 v43, v43
  v_mfma_f32_16x16x32_bf16 v[216:219], a[184:187], v[48:51], v[216:219]
  ds_read_b128 a[88:91], v6 offset:4096
  v_cvt_pk_bf16_f32 v53, v42, v43
  v_mfma_f32_16x16x32_bf16 v[220:223], a[188:191], v[48:51], v[220:223]
  s_add_u32 m0, s41, 65536
  v_exp_f32_e64 v44, v44
  v_mfma_f32_16x16x32_bf16 v[32:35], a[96:99], a[0:3], v[56:59]
  buffer_load_dwordx4 v20, s[12:15], s43 offen offset:0 nt lds
  v_mfma_f32_16x16x32_bf16 v[32:35], a[100:103], a[4:7], v[32:35]
  v_exp_f32_e64 v45, v45
  v_mfma_f32_16x16x32_bf16 v[32:35], a[104:107], a[8:11], v[32:35]
  ds_read_b128 a[84:87], v5 offset:4096
  v_cvt_pk_bf16_f32 v54, v44, v45
  v_mfma_f32_16x16x32_bf16 v[32:35], a[108:111], a[12:15], v[32:35]
  v_exp_f32_e64 v46, v46
  v_mfma_f32_16x16x32_bf16 v[36:39], a[124:127], a[12:15], v[56:59]
  ds_read_b128 a[80:83], v4 offset:4096
  v_mfma_f32_16x16x32_bf16 v[36:39], a[120:123], a[8:11], v[36:39]
  v_exp_f32_e64 v47, v47
  v_mfma_f32_16x16x32_bf16 v[36:39], a[116:119], a[4:7], v[36:39]
  ds_read_b64_tr_b16 a[128:129], v8 offset:32768
  v_cvt_pk_bf16_f32 v55, v46, v47
  v_mfma_f32_16x16x32_bf16 v[36:39], a[112:115], a[0:3], v[36:39]
  v_exp_f32_e64 v32, v32
  v_smfmac_f32_16x16x64_bf16 v[108:111], v[120:123], v[48:55], v78
  ds_read_b64_tr_b16 a[130:131], v8 offset:36864
  buffer_load_dwordx4 v21, s[12:15], s43 offen offset:1024 nt lds
  v_mfma_f32_16x16x32_bf16 v[224:227], a[160:163], v[52:55], v[224:227]
  v_exp_f32_e64 v33, v33
  v_mfma_f32_16x16x32_bf16 v[228:231], a[164:167], v[52:55], v[228:231]
  v_cvt_pk_bf16_f32 v48, v32, v33
  v_mfma_f32_16x16x32_bf16 v[232:235], a[168:171], v[52:55], v[232:235]
  v_exp_f32_e64 v34, v34
  v_mfma_f32_16x16x32_bf16 v[236:239], a[172:175], v[52:55], v[236:239]
  ds_read_b64_tr_b16 a[132:133], v9 offset:32768
  buffer_load_dwordx4 v20, s[12:15], s43 offen offset:2048 nt lds
  v_mfma_f32_16x16x32_bf16 v[240:243], a[176:179], v[52:55], v[240:243]
  v_exp_f32_e64 v35, v35
  v_mfma_f32_16x16x32_bf16 v[244:247], a[180:183], v[52:55], v[244:247]
  ds_read_b64_tr_b16 a[134:135], v9 offset:36864
  v_cvt_pk_bf16_f32 v49, v34, v35
  v_mfma_f32_16x16x32_bf16 v[248:251], a[184:187], v[52:55], v[248:251]
  v_exp_f32_e64 v36, v36
  v_mfma_f32_16x16x32_bf16 v[252:255], a[188:191], v[52:55], v[252:255]
  ds_read_b64_tr_b16 a[136:137], v10 offset:32768
  v_mfma_f32_16x16x32_bf16 v[40:43], a[96:99], a[16:19], v[60:63]
  v_exp_f32_e64 v37, v37
  v_mfma_f32_16x16x32_bf16 v[40:43], a[100:103], a[20:23], v[40:43]
  v_cvt_pk_bf16_f32 v50, v36, v37
  v_mfma_f32_16x16x32_bf16 v[40:43], a[104:107], a[24:27], v[40:43]
  v_exp_f32_e64 v38, v38
  v_mfma_f32_16x16x32_bf16 v[40:43], a[108:111], a[28:31], v[40:43]
  ds_read_b64_tr_b16 a[138:139], v10 offset:36864
  v_mfma_f32_16x16x32_bf16 v[44:47], a[124:127], a[28:31], v[60:63]
  v_exp_f32_e64 v39, v39
  v_mfma_f32_16x16x32_bf16 v[44:47], a[120:123], a[24:27], v[44:47]
  ds_read_b64_tr_b16 a[140:141], v11 offset:32768
  v_cvt_pk_bf16_f32 v51, v38, v39
  v_mfma_f32_16x16x32_bf16 v[44:47], a[116:119], a[20:23], v[44:47]
  buffer_load_dwordx4 v21, s[12:15], s43 offen offset:3072 nt lds
  v_mfma_f32_16x16x32_bf16 v[44:47], a[112:115], a[16:19], v[44:47]
  v_exp_f32_e64 v40, v40
  v_mfma_f32_16x16x32_bf16 v[128:131], a[160:163], v[48:51], v[128:131]
  ds_read_b64_tr_b16 a[142:143], v11 offset:36864
  v_mfma_f32_16x16x32_bf16 v[132:135], a[164:167], v[48:51], v[132:135]
  v_exp_f32_e64 v41, v41
  v_mfma_f32_16x16x32_bf16 v[136:139], a[168:171], v[48:51], v[136:139]
  ds_read_b64_tr_b16 a[144:145], v12 offset:32768
  v_cvt_pk_bf16_f32 v52, v40, v41
  v_mfma_f32_16x16x32_bf16 v[140:143], a[172:175], v[48:51], v[140:143]
  s_add_u32 s48, s48, 1
  v_exp_f32 v42, v42
  v_mfma_f32_16x16x32_bf16 v[144:147], a[176:179], v[48:51], v[144:147]
  s_cbranch_scc0 L_att
  v_mfma_f32_16x16x32_bf16 v[148:151], a[180:183], v[48:51], v[148:151]
  v_exp_f32 v43, v43
  v_mfma_f32_16x16x32_bf16 v[152:155], a[184:187], v[48:51], v[152:155]
  ds_read_b64_tr_b16 a[146:147], v12 offset:36864
  v_cvt_pk_bf16_f32 v53, v42, v43
  v_mfma_f32_16x16x32_bf16 v[156:159], a[188:191], v[48:51], v[156:159]
  s_waitcnt lgkmcnt(3)
  v_exp_f32 v44, v44
  v_mfma_f32_16x16x32_bf16 v[32:35], a[64:67], a[32:35], v[64:67]
  ds_read_b64_tr_b16 a[148:149], v13 offset:32768
  v_mfma_f32_16x16x32_bf16 v[32:35], a[68:71], a[36:39], v[32:35]
  v_exp_f32_e64 v45, v45
  v_mfma_f32_16x16x32_bf16 v[32:35], a[72:75], a[40:43], v[32:35]
  ds_read_b64_tr_b16 a[150:151], v13 offset:36864
  v_cvt_pk_bf16_f32 v54, v44, v45
  v_mfma_f32_16x16x32_bf16 v[32:35], a[76:79], a[44:47], v[32:35]
  s_sub_u32 s43, s43, s57
  v_exp_f32 v46, v46
  v_mfma_f32_16x16x32_bf16 v[36:39], a[92:95], a[44:47], v[64:67]
  ds_read_b64_tr_b16 a[152:153], v14 offset:32768
  v_mfma_f32_16x16x32_bf16 v[36:39], a[88:91], a[40:43], v[36:39]
  s_and_b32 s43, s43, s57
  v_exp_f32 v47, v47
  v_mfma_f32_16x16x32_bf16 v[36:39], a[84:87], a[36:39], v[36:39]
  ds_read_b64_tr_b16 a[154:155], v14 offset:36864
  v_cvt_pk_bf16_f32 v55, v46, v47
  v_mfma_f32_16x16x32_bf16 v[36:39], a[80:83], a[32:35], v[36:39]
  s_add_u32 m0, s41, 49152
  v_exp_f32_e64 v32, v32
  v_smfmac_f32_16x16x64_bf16 v[104:107], v[120:123], v[48:55], v78
  ds_read_b64_tr_b16 a[156:157], v15 offset:32768
  buffer_load_dwordx4 v16, s[8:11], s43 offen offset:0 nt lds
  v_mfma_f32_16x16x32_bf16 v[160:163], a[160:163], v[52:55], v[160:163]
  v_exp_f32_e64 v33, v33
  v_mfma_f32_16x16x32_bf16 v[164:167], a[164:167], v[52:55], v[164:167]
  v_cvt_pk_bf16_f32 v48, v32, v33
  v_mfma_f32_16x16x32_bf16 v[168:171], a[168:171], v[52:55], v[168:171]
  v_exp_f32_e64 v34, v34
  v_mfma_f32_16x16x32_bf16 v[172:175], a[172:175], v[52:55], v[172:175]
  ds_read_b64_tr_b16 a[158:159], v15 offset:36864
  v_mfma_f32_16x16x32_bf16 v[176:179], a[176:179], v[52:55], v[176:179]
  v_exp_f32_e64 v35, v35
  v_mfma_f32_16x16x32_bf16 v[180:183], a[180:183], v[52:55], v[180:183]
  v_cvt_pk_bf16_f32 v49, v34, v35
  v_mfma_f32_16x16x32_bf16 v[184:187], a[184:187], v[52:55], v[184:187]
  v_exp_f32_e64 v36, v36
  v_mfma_f32_16x16x32_bf16 v[188:191], a[188:191], v[52:55], v[188:191]
  buffer_load_dwordx4 v17, s[8:11], s43 offen offset:1024 nt lds
  v_mfma_f32_16x16x32_bf16 v[40:43], a[64:67], a[48:51], v[68:71]
  v_exp_f32_e64 v37, v37
  v_mfma_f32_16x16x32_bf16 v[40:43], a[68:71], a[52:55], v[40:43]
  v_cvt_pk_bf16_f32 v50, v36, v37
  v_mfma_f32_16x16x32_bf16 v[40:43], a[72:75], a[56:59], v[40:43]
  s_waitcnt vmcnt(10) lgkmcnt(0)
  v_exp_f32 v38, v38
  v_mfma_f32_16x16x32_bf16 v[40:43], a[76:79], a[60:63], v[40:43]
  s_barrier
  ds_read_b128 a[96:99], v4 offset:16384
  v_mfma_f32_16x16x32_bf16 v[44:47], a[92:95], a[60:63], v[68:71]
  v_exp_f32 v39, v39
  v_mfma_f32_16x16x32_bf16 v[44:47], a[88:91], a[56:59], v[44:47]
  ds_read_b128 a[100:103], v5 offset:16384
  v_cvt_pk_bf16_f32 v51, v38, v39
  v_mfma_f32_16x16x32_bf16 v[44:47], a[84:87], a[52:55], v[44:47]
  buffer_load_dwordx4 v18, s[8:11], s43 offen offset:2048 nt lds
  v_mfma_f32_16x16x32_bf16 v[44:47], a[80:83], a[48:51], v[44:47]
  v_exp_f32_e64 v40, v40
  v_mfma_f32_16x16x32_bf16 v[192:195], a[128:131], v[48:51], v[192:195]
  ds_read_b128 a[104:107], v6 offset:16384
  buffer_load_dwordx4 v19, s[8:11], s43 offen offset:3072 nt lds
  v_mfma_f32_16x16x32_bf16 v[196:199], a[132:135], v[48:51], v[196:199]
  v_exp_f32_e64 v41, v41
  v_mfma_f32_16x16x32_bf16 v[200:203], a[136:139], v[48:51], v[200:203]
  ds_read_b128 a[108:111], v7 offset:16384
  v_cvt_pk_bf16_f32 v52, v40, v41
  v_mfma_f32_16x16x32_bf16 v[204:207], a[140:143], v[48:51], v[204:207]
  v_exp_f32_e64 v42, v42
  v_mfma_f32_16x16x32_bf16 v[208:211], a[144:147], v[48:51], v[208:211]
  ds_read_b128 a[124:127], v7 offset:20480
  v_mfma_f32_16x16x32_bf16 v[212:215], a[148:151], v[48:51], v[212:215]
  v_exp_f32_e64 v43, v43
  v_mfma_f32_16x16x32_bf16 v[216:219], a[152:155], v[48:51], v[216:219]
  ds_read_b128 a[120:123], v6 offset:20480
  v_cvt_pk_bf16_f32 v53, v42, v43
  v_mfma_f32_16x16x32_bf16 v[220:223], a[156:159], v[48:51], v[220:223]
  s_add_u32 m0, s41, 81920
  v_exp_f32_e64 v44, v44
  v_mfma_f32_16x16x32_bf16 v[32:35], a[64:67], a[0:3], v[56:59]
L_w3:
  s_cbranch_execz L_wdone
  buffer_load_dwordx4 v20, s[12:15], s43 offen offset:0 nt lds
  v_mfma_f32_16x16x32_bf16 v[32:35], a[68:71], a[4:7], v[32:35]
  v_exp_f32 v45, v45
  v_mfma_f32_16x16x32_bf16 v[32:35], a[72:75], a[8:11], v[32:35]
  ds_read_b128 a[116:119], v5 offset:20480
  v_cvt_pk_bf16_f32 v54, v44, v45
  v_mfma_f32_16x16x32_bf16 v[32:35], a[76:79], a[12:15], v[32:35]
  v_exp_f32_e64 v46, v46
  v_mfma_f32_16x16x32_bf16 v[36:39], a[92:95], a[12:15], v[56:59]
  ds_read_b128 a[112:115], v4 offset:20480
  v_mfma_f32_16x16x32_bf16 v[36:39], a[88:91], a[8:11], v[36:39]
  v_exp_f32_e64 v47, v47
  v_mfma_f32_16x16x32_bf16 v[36:39], a[84:87], a[4:7], v[36:39]
  ds_read_b64_tr_b16 a[160:161], v8 offset:49152
  v_cvt_pk_bf16_f32 v55, v46, v47
  v_mfma_f32_16x16x32_bf16 v[36:39], a[80:83], a[0:3], v[36:39]
  v_exp_f32_e64 v32, v32
  v_smfmac_f32_16x16x64_bf16 v[108:111], v[120:123], v[48:55], v78
  ds_read_b64_tr_b16 a[162:163], v8 offset:53248
  buffer_load_dwordx4 v21, s[12:15], s43 offen offset:1024 nt lds
  v_mfma_f32_16x16x32_bf16 v[224:227], a[128:131], v[52:55], v[224:227]
  v_exp_f32_e64 v33, v33
  v_mfma_f32_16x16x32_bf16 v[228:231], a[132:135], v[52:55], v[228:231]
  v_cvt_pk_bf16_f32 v48, v32, v33
  v_mfma_f32_16x16x32_bf16 v[232:235], a[136:139], v[52:55], v[232:235]
  v_exp_f32_e64 v34, v34
  v_mfma_f32_16x16x32_bf16 v[236:239], a[140:143], v[52:55], v[236:239]
  ds_read_b64_tr_b16 a[164:165], v9 offset:49152
  buffer_load_dwordx4 v20, s[12:15], s43 offen offset:2048 nt lds
  v_mfma_f32_16x16x32_bf16 v[240:243], a[144:147], v[52:55], v[240:243]
  v_exp_f32_e64 v35, v35
  v_mfma_f32_16x16x32_bf16 v[244:247], a[148:151], v[52:55], v[244:247]
  ds_read_b64_tr_b16 a[166:167], v9 offset:53248
  v_cvt_pk_bf16_f32 v49, v34, v35
  v_mfma_f32_16x16x32_bf16 v[248:251], a[152:155], v[52:55], v[248:251]
  v_exp_f32_e64 v36, v36
  v_mfma_f32_16x16x32_bf16 v[252:255], a[156:159], v[52:55], v[252:255]
  ds_read_b64_tr_b16 a[168:169], v10 offset:49152
  v_mfma_f32_16x16x32_bf16 v[40:43], a[64:67], a[16:19], v[60:63]
  v_exp_f32_e64 v37, v37
  v_mfma_f32_16x16x32_bf16 v[40:43], a[68:71], a[20:23], v[40:43]
  v_cvt_pk_bf16_f32 v50, v36, v37
  v_mfma_f32_16x16x32_bf16 v[40:43], a[72:75], a[24:27], v[40:43]
  v_exp_f32_e64 v38, v38
  v_mfma_f32_16x16x32_bf16 v[40:43], a[76:79], a[28:31], v[40:43]
  ds_read_b64_tr_b16 a[170:171], v10 offset:53248
  v_mfma_f32_16x16x32_bf16 v[44:47], a[92:95], a[28:31], v[60:63]
  v_exp_f32_e64 v39, v39
  v_mfma_f32_16x16x32_bf16 v[44:47], a[88:91], a[24:27], v[44:47]
  ds_read_b64_tr_b16 a[172:173], v11 offset:49152
  v_cvt_pk_bf16_f32 v51, v38, v39
  v_mfma_f32_16x16x32_bf16 v[44:47], a[84:87], a[20:23], v[44:47]
  buffer_load_dwordx4 v21, s[12:15], s43 offen offset:3072 nt lds
  v_mfma_f32_16x16x32_bf16 v[44:47], a[80:83], a[16:19], v[44:47]
  v_exp_f32_e64 v40, v40
  v_mfma_f32_16x16x32_bf16 v[128:131], a[128:131], v[48:51], v[128:131]
  ds_read_b64_tr_b16 a[174:175], v11 offset:53248
  v_mfma_f32_16x16x32_bf16 v[132:135], a[132:135], v[48:51], v[132:135]
  v_exp_f32_e64 v41, v41
  v_mfma_f32_16x16x32_bf16 v[136:139], a[136:139], v[48:51], v[136:139]
  ds_read_b64_tr_b16 a[176:177], v12 offset:49152
  v_cvt_pk_bf16_f32 v52, v40, v41
  v_mfma_f32_16x16x32_bf16 v[140:143], a[140:143], v[48:51], v[140:143]
  v_exp_f32_e64 v42, v42
  v_mfma_f32_16x16x32_bf16 v[144:147], a[144:147], v[48:51], v[144:147]
  ds_read_b64_tr_b16 a[178:179], v12 offset:53248
  v_mfma_f32_16x16x32_bf16 v[148:151], a[148:151], v[48:51], v[148:151]
  v_exp_f32_e64 v43, v43
  v_mfma_f32_16x16x32_bf16 v[152:155], a[152:155], v[48:51], v[152:155]
  ds_read_b64_tr_b16 a[180:181], v13 offset:49152
  v_cvt_pk_bf16_f32 v53, v42, v43
  v_mfma_f32_16x16x32_bf16 v[156:159], a[156:159], v[48:51], v[156:159]
  s_waitcnt lgkmcnt(4)
  v_exp_f32 v44, v44
  v_mfma_f32_16x16x32_bf16 v[32:35], a[96:99], a[32:35], v[64:67]
  v_mfma_f32_16x16x32_bf16 v[32:35], a[100:103], a[36:39], v[32:35]
  v_exp_f32_e64 v45, v45
  v_mfma_f32_16x16x32_bf16 v[32:35], a[104:107], a[40:43], v[32:35]
  ds_read_b64_tr_b16 a[182:183], v13 offset:53248
  v_cvt_pk_bf16_f32 v54, v44, v45
  v_mfma_f32_16x16x32_bf16 v[32:35], a[108:111], a[44:47], v[32:35]
  s_sub_u32 s43, s43, s57
  v_exp_f32 v46, v46
  v_mfma_f32_16x16x32_bf16 v[36:39], a[124:127], a[44:47], v[64:67]
  ds_read_b64_tr_b16 a[184:185], v14 offset:49152
  v_mfma_f32_16x16x32_bf16 v[36:39], a[120:123], a[40:43], v[36:39]
  s_and_b32 s43, s43, s57
  v_exp_f32 v47, v47
  v_mfma_f32_16x16x32_bf16 v[36:39], a[116:119], a[36:39], v[36:39]
  ds_read_b64_tr_b16 a[186:187], v14 offset:53248
  v_cvt_pk_bf16_f32 v55, v46, v47
  v_mfma_f32_16x16x32_bf16 v[36:39], a[112:115], a[32:35], v[36:39]
  s_and_b32 m0, s41, 0xffff
  v_exp_f32_e64 v32, v32
  v_smfmac_f32_16x16x64_bf16 v[104:107], v[120:123], v[48:55], v78
  ds_read_b64_tr_b16 a[188:189], v15 offset:49152
  buffer_load_dwordx4 v16, s[8:11], s43 offen offset:0 nt lds
  v_mfma_f32_16x16x32_bf16 v[160:163], a[128:131], v[52:55], v[160:163]
  v_exp_f32_e64 v33, v33
  v_mfma_f32_16x16x32_bf16 v[164:167], a[132:135], v[52:55], v[164:167]
  v_cvt_pk_bf16_f32 v48, v32, v33
  v_mfma_f32_16x16x32_bf16 v[168:171], a[136:139], v[52:55], v[168:171]
  v_exp_f32_e64 v34, v34
  v_mfma_f32_16x16x32_bf16 v[172:175], a[140:143], v[52:55], v[172:175]
  ds_read_b64_tr_b16 a[190:191], v15 offset:53248
  v_mfma_f32_16x16x32_bf16 v[176:179], a[144:147], v[52:55], v[176:179]
  v_exp_f32_e64 v35, v35
  v_mfma_f32_16x16x32_bf16 v[180:183], a[148:151], v[52:55], v[180:183]
  v_cvt_pk_bf16_f32 v49, v34, v35
  v_mfma_f32_16x16x32_bf16 v[184:187], a[152:155], v[52:55], v[184:187]
  v_exp_f32_e64 v36, v36
  v_mfma_f32_16x16x32_bf16 v[188:191], a[156:159], v[52:55], v[188:191]
  buffer_load_dwordx4 v17, s[8:11], s43 offen offset:1024 nt lds
  v_mfma_f32_16x16x32_bf16 v[40:43], a[96:99], a[48:51], v[68:71]
  v_exp_f32_e64 v37, v37
  v_mfma_f32_16x16x32_bf16 v[40:43], a[100:103], a[52:55], v[40:43]
  v_cvt_pk_bf16_f32 v50, v36, v37
  v_mfma_f32_16x16x32_bf16 v[40:43], a[104:107], a[56:59], v[40:43]
  s_waitcnt vmcnt(10) lgkmcnt(0)
  v_exp_f32 v38, v38
  v_mfma_f32_16x16x32_bf16 v[40:43], a[108:111], a[60:63], v[40:43]
  s_barrier
  ds_read_b128 a[64:67], v4 offset:32768
  v_mfma_f32_16x16x32_bf16 v[44:47], a[124:127], a[60:63], v[68:71]
  v_exp_f32 v39, v39
  v_mfma_f32_16x16x32_bf16 v[44:47], a[120:123], a[56:59], v[44:47]
  ds_read_b128 a[68:71], v5 offset:32768
  v_cvt_pk_bf16_f32 v51, v38, v39
  v_mfma_f32_16x16x32_bf16 v[44:47], a[116:119], a[52:55], v[44:47]
  buffer_load_dwordx4 v18, s[8:11], s43 offen offset:2048 nt lds
  v_mfma_f32_16x16x32_bf16 v[44:47], a[112:115], a[48:51], v[44:47]
  v_exp_f32_e64 v40, v40
  v_mfma_f32_16x16x32_bf16 v[192:195], a[160:163], v[48:51], v[192:195]
  ds_read_b128 a[72:75], v6 offset:32768
  buffer_load_dwordx4 v19, s[8:11], s43 offen offset:3072 nt lds
  v_mfma_f32_16x16x32_bf16 v[196:199], a[164:167], v[48:51], v[196:199]
  v_exp_f32_e64 v41, v41
  v_mfma_f32_16x16x32_bf16 v[200:203], a[168:171], v[48:51], v[200:203]
  ds_read_b128 a[76:79], v7 offset:32768
  v_cvt_pk_bf16_f32 v52, v40, v41
  v_mfma_f32_16x16x32_bf16 v[204:207], a[172:175], v[48:51], v[204:207]
  v_exp_f32_e64 v42, v42
  v_mfma_f32_16x16x32_bf16 v[208:211], a[176:179], v[48:51], v[208:211]
  ds_read_b128 a[92:95], v7 offset:36864
  v_mfma_f32_16x16x32_bf16 v[212:215], a[180:183], v[48:51], v[212:215]
  v_exp_f32_e64 v43, v43
  v_mfma_f32_16x16x32_bf16 v[216:219], a[184:187], v[48:51], v[216:219]
  ds_read_b128 a[88:91], v6 offset:36864
  v_cvt_pk_bf16_f32 v53, v42, v43
  v_mfma_f32_16x16x32_bf16 v[220:223], a[188:191], v[48:51], v[220:223]
  s_add_u32 m0, s41, 98304
  v_exp_f32_e64 v44, v44
  v_mfma_f32_16x16x32_bf16 v[32:35], a[96:99], a[0:3], v[56:59]
  buffer_load_dwordx4 v20, s[12:15], s43 offen offset:0 nt lds
  v_mfma_f32_16x16x32_bf16 v[32:35], a[100:103], a[4:7], v[32:35]
  v_exp_f32_e64 v45, v45
  v_mfma_f32_16x16x32_bf16 v[32:35], a[104:107], a[8:11], v[32:35]
  ds_read_b128 a[84:87], v5 offset:36864
  v_cvt_pk_bf16_f32 v54, v44, v45
  v_mfma_f32_16x16x32_bf16 v[32:35], a[108:111], a[12:15], v[32:35]
  v_exp_f32_e64 v46, v46
  v_mfma_f32_16x16x32_bf16 v[36:39], a[124:127], a[12:15], v[56:59]
  ds_read_b128 a[80:83], v4 offset:36864
  v_mfma_f32_16x16x32_bf16 v[36:39], a[120:123], a[8:11], v[36:39]
  v_exp_f32_e64 v47, v47
  v_mfma_f32_16x16x32_bf16 v[36:39], a[116:119], a[4:7], v[36:39]
  ds_read_b64_tr_b16 a[128:129], v8 offset:0
  v_cvt_pk_bf16_f32 v55, v46, v47
  v_mfma_f32_16x16x32_bf16 v[36:39], a[112:115], a[0:3], v[36:39]
  v_exp_f32_e64 v32, v32
  v_smfmac_f32_16x16x64_bf16 v[108:111], v[120:123], v[48:55], v78
  ds_read_b64_tr_b16 a[130:131], v8 offset:4096
  buffer_load_dwordx4 v21, s[12:15], s43 offen offset:1024 nt lds
  v_mfma_f32_16x16x32_bf16 v[224:227], a[160:163], v[52:55], v[224:227]
  v_exp_f32_e64 v33, v33
  v_mfma_f32_16x16x32_bf16 v[228:231], a[164:167], v[52:55], v[228:231]
  v_cvt_pk_bf16_f32 v48, v32, v33
  v_mfma_f32_16x16x32_bf16 v[232:235], a[168:171], v[52:55], v[232:235]
  v_exp_f32_e64 v34, v34
  v_mfma_f32_16x16x32_bf16 v[236:239], a[172:175], v[52:55], v[236:239]
  ds_read_b64_tr_b16 a[132:133], v9 offset:0
  buffer_load_dwordx4 v20, s[12:15], s43 offen offset:2048 nt lds
  v_mfma_f32_16x16x32_bf16 v[240:243], a[176:179], v[52:55], v[240:243]
  v_exp_f32_e64 v35, v35
  v_mfma_f32_16x16x32_bf16 v[244:247], a[180:183], v[52:55], v[244:247]
  ds_read_b64_tr_b16 a[134:135], v9 offset:4096
  v_cvt_pk_bf16_f32 v49, v34, v35
  v_mfma_f32_16x16x32_bf16 v[248:251], a[184:187], v[52:55], v[248:251]
  v_exp_f32_e64 v36, v36
  v_mfma_f32_16x16x32_bf16 v[252:255], a[188:191], v[52:55], v[252:255]
  ds_read_b64_tr_b16 a[136:137], v10 offset:0
  v_mfma_f32_16x16x32_bf16 v[40:43], a[96:99], a[16:19], v[60:63]
  v_exp_f32_e64 v37, v37
  v_mfma_f32_16x16x32_bf16 v[40:43], a[100:103], a[20:23], v[40:43]
  v_cvt_pk_bf16_f32 v50, v36, v37
  v_mfma_f32_16x16x32_bf16 v[40:43], a[104:107], a[24:27], v[40:43]
  v_exp_f32_e64 v38, v38
  v_mfma_f32_16x16x32_bf16 v[40:43], a[108:111], a[28:31], v[40:43]
  ds_read_b64_tr_b16 a[138:139], v10 offset:4096
  v_mfma_f32_16x16x32_bf16 v[44:47], a[124:127], a[28:31], v[60:63]
  v_exp_f32_e64 v39, v39
  v_mfma_f32_16x16x32_bf16 v[44:47], a[120:123], a[24:27], v[44:47]
  ds_read_b64_tr_b16 a[140:141], v11 offset:0
  v_cvt_pk_bf16_f32 v51, v38, v39
  v_mfma_f32_16x16x32_bf16 v[44:47], a[116:119], a[20:23], v[44:47]
  buffer_load_dwordx4 v21, s[12:15], s43 offen offset:3072 nt lds
  v_mfma_f32_16x16x32_bf16 v[44:47], a[112:115], a[16:19], v[44:47]
  v_exp_f32_e64 v40, v40
  v_mfma_f32_16x16x32_bf16 v[128:131], a[160:163], v[48:51], v[128:131]
  ds_read_b64_tr_b16 a[142:143], v11 offset:4096
  v_mfma_f32_16x16x32_bf16 v[132:135], a[164:167], v[48:51], v[132:135]
  v_exp_f32_e64 v41, v41
  v_mfma_f32_16x16x32_bf16 v[136:139], a[168:171], v[48:51], v[136:139]
  ds_read_b64_tr_b16 a[144:145], v12 offset:0
  v_cvt_pk_bf16_f32 v52, v40, v41
  v_mfma_f32_16x16x32_bf16 v[140:143], a[172:175], v[48:51], v[140:143]
  v_exp_f32_e64 v42, v42
  v_mfma_f32_16x16x32_bf16 v[144:147], a[176:179], v[48:51], v[144:147]
  ds_read_b64_tr_b16 a[146:147], v12 offset:4096
  v_mfma_f32_16x16x32_bf16 v[148:151], a[180:183], v[48:51], v[148:151]
  v_exp_f32_e64 v43, v43
  v_mfma_f32_16x16x32_bf16 v[152:155], a[184:187], v[48:51], v[152:155]
  ds_read_b64_tr_b16 a[148:149], v13 offset:0
  v_cvt_pk_bf16_f32 v53, v42, v43
  v_mfma_f32_16x16x32_bf16 v[156:159], a[188:191], v[48:51], v[156:159]
  s_waitcnt lgkmcnt(4)
  v_exp_f32 v44, v44
  v_mfma_f32_16x16x32_bf16 v[32:35], a[64:67], a[32:35], v[64:67]
  v_mfma_f32_16x16x32_bf16 v[32:35], a[68:71], a[36:39], v[32:35]
  v_exp_f32_e64 v45, v45
  v_mfma_f32_16x16x32_bf16 v[32:35], a[72:75], a[40:43], v[32:35]
  v_cvt_pk_bf16_f32 v54, v44, v45
  ds_read_b64_tr_b16 a[150:151], v13 offset:4096
  v_mfma_f32_16x16x32_bf16 v[32:35], a[76:79], a[44:47], v[32:35]
  s_sub_u32 s43, s43, s57
  v_exp_f32 v46, v46
  v_mfma_f32_16x16x32_bf16 v[36:39], a[92:95], a[44:47], v[64:67]
  ds_read_b64_tr_b16 a[152:153], v14 offset:0
  v_mfma_f32_16x16x32_bf16 v[36:39], a[88:91], a[40:43], v[36:39]
  s_and_b32 s43, s43, s57
  v_exp_f32 v47, v47
  v_mfma_f32_16x16x32_bf16 v[36:39], a[84:87], a[36:39], v[36:39]
  v_cvt_pk_bf16_f32 v55, v46, v47
  ds_read_b64_tr_b16 a[154:155], v14 offset:4096
  v_mfma_f32_16x16x32_bf16 v[36:39], a[80:83], a[32:35], v[36:39]
  s_add_u32 m0, s41, 16384
  v_exp_f32_e64 v32, v32
  v_smfmac_f32_16x16x64_bf16 v[104:107], v[120:123], v[48:55], v78
  buffer_load_dwordx4 v16, s[8:11], s43 offen offset:0 nt lds
  ds_read_b64_tr_b16 a[156:157], v15 offset:0
  v_mfma_f32_16x16x32_bf16 v[160:163], a[160:163], v[52:55], v[160:163]
  v_exp_f32_e64 v33, v33
  v_mfma_f32_16x16x32_bf16 v[164:167], a[164:167], v[52:55], v[164:167]
  v_cvt_pk_bf16_f32 v48, v32, v33
  v_mfma_f32_16x16x32_bf16 v[168:171], a[168:171], v[52:55], v[168:171]
  v_exp_f32_e64 v34, v34
  v_mfma_f32_16x16x32_bf16 v[172:175], a[172:175], v[52:55], v[172:175]
  ds_read_b64_tr_b16 a[158:159], v15 offset:4096
  v_mfma_f32_16x16x32_bf16 v[176:179], a[176:179], v[52:55], v[176:179]
  v_exp_f32_e64 v35, v35
  v_mfma_f32_16x16x32_bf16 v[180:183], a[180:183], v[52:55], v[180:183]
  v_cvt_pk_bf16_f32 v49, v34, v35
  v_mfma_f32_16x16x32_bf16 v[184:187], a[184:187], v[52:55], v[184:187]
  v_exp_f32_e64 v36, v36
  v_mfma_f32_16x16x32_bf16 v[188:191], a[188:191], v[52:55], v[188:191]
  buffer_load_dwordx4 v17, s[8:11], s43 offen offset:1024 nt lds
  v_mfma_f32_16x16x32_bf16 v[40:43], a[64:67], a[48:51], v[68:71]
  v_exp_f32_e64 v37, v37
  v_mfma_f32_16x16x32_bf16 v[40:43], a[68:71], a[52:55], v[40:43]
  v_cvt_pk_bf16_f32 v50, v36, v37
  v_mfma_f32_16x16x32_bf16 v[40:43], a[72:75], a[56:59], v[40:43]
  s_waitcnt vmcnt(10) lgkmcnt(0)
  v_exp_f32 v38, v38
  v_mfma_f32_16x16x32_bf16 v[40:43], a[76:79], a[60:63], v[40:43]
  s_barrier
  ds_read_b128 a[96:99], v4 offset:49152
  v_mfma_f32_16x16x32_bf16 v[44:47], a[92:95], a[60:63], v[68:71]
  v_exp_f32 v39, v39
  v_mfma_f32_16x16x32_bf16 v[44:47], a[88:91], a[56:59], v[44:47]
  v_cvt_pk_bf16_f32 v51, v38, v39
  ds_read_b128 a[100:103], v5 offset:49152
  v_mfma_f32_16x16x32_bf16 v[44:47], a[84:87], a[52:55], v[44:47]
  buffer_load_dwordx4 v18, s[8:11], s43 offen offset:2048 nt lds
  v_mfma_f32_16x16x32_bf16 v[44:47], a[80:83], a[48:51], v[44:47]
  v_exp_f32_e64 v40, v40
  v_mfma_f32_16x16x32_bf16 v[192:195], a[128:131], v[48:51], v[192:195]
  buffer_load_dwordx4 v19, s[8:11], s43 offen offset:3072 nt lds
  ds_read_b128 a[104:107], v6 offset:49152
  v_mfma_f32_16x16x32_bf16 v[196:199], a[132:135], v[48:51], v[196:199]
  v_exp_f32_e64 v41, v41
  v_mfma_f32_16x16x32_bf16 v[200:203], a[136:139], v[48:51], v[200:203]
  v_cvt_pk_bf16_f32 v52, v40, v41
  ds_read_b128 a[108:111], v7 offset:49152
  v_mfma_f32_16x16x32_bf16 v[204:207], a[140:143], v[48:51], v[204:207]
  v_exp_f32_e64 v42, v42
  v_mfma_f32_16x16x32_bf16 v[208:211], a[144:147], v[48:51], v[208:211]
  ds_read_b128 a[124:127], v7 offset:53248
  v_mfma_f32_16x16x32_bf16 v[212:215], a[148:151], v[48:51], v[212:215]
  v_exp_f32_e64 v43, v43
  v_mfma_f32_16x16x32_bf16 v[216:219], a[152:155], v[48:51], v[216:219]
  v_cvt_pk_bf16_f32 v53, v42, v43
  ds_read_b128 a[120:123], v6 offset:53248
  v_mfma_f32_16x16x32_bf16 v[220:223], a[156:159], v[48:51], v[220:223]
  s_add_u32 m0, s41, 114688
  v_exp_f32_e64 v44, v44
  v_mfma_f32_16x16x32_bf16 v[32:35], a[64:67], a[0:3], v[56:59]
  buffer_load_dwordx4 v20, s[12:15], s43 offen offset:0 nt lds
  v_mfma_f32_16x16x32_bf16 v[32:35], a[68:71], a[4:7], v[32:35]
  v_exp_f32_e64 v45, v45
  v_mfma_f32_16x16x32_bf16 v[32:35], a[72:75], a[8:11], v[32:35]
  v_cvt_pk_bf16_f32 v54, v44, v45
  ds_read_b128 a[116:119], v5 offset:53248
  v_mfma_f32_16x16x32_bf16 v[32:35], a[76:79], a[12:15], v[32:35]
  v_exp_f32_e64 v46, v46
  v_mfma_f32_16x16x32_bf16 v[36:39], a[92:95], a[12:15], v[56:59]
  ds_read_b128 a[112:115], v4 offset:53248
  v_mfma_f32_16x16x32_bf16 v[36:39], a[88:91], a[8:11], v[36:39]
  v_exp_f32_e64 v47, v47
  v_mfma_f32_16x16x32_bf16 v[36:39], a[84:87], a[4:7], v[36:39]
  v_cvt_pk_bf16_f32 v55, v46, v47
  ds_read_b64_tr_b16 a[160:161], v8 offset:16384
  v_mfma_f32_16x16x32_bf16 v[36:39], a[80:83], a[0:3], v[36:39]
  v_exp_f32_e64 v32, v32
  v_smfmac_f32_16x16x64_bf16 v[108:111], v[120:123], v[48:55], v78
  buffer_load_dwordx4 v21, s[12:15], s43 offen offset:1024 nt lds
  ds_read_b64_tr_b16 a[162:163], v8 offset:20480
  v_mfma_f32_16x16x32_bf16 v[224:227], a[128:131], v[52:55], v[224:227]
  v_exp_f32_e64 v33, v33
  v_mfma_f32_16x16x32_bf16 v[228:231], a[132:135], v[52:55], v[228:231]
  v_cvt_pk_bf16_f32 v48, v32, v33
  v_mfma_f32_16x16x32_bf16 v[232:235], a[136:139], v[52:55], v[232:235]
  v_exp_f32_e64 v34, v34
  v_mfma_f32_16x16x32_bf16 v[236:239], a[140:143], v[52:55], v[236:239]
  buffer_load_dwordx4 v20, s[12:15], s43 offen offset:2048 nt lds
  ds_read_b64_tr_b16 a[164:165], v9 offset:16384
  v_mfma_f32_16x16x32_bf16 v[240:243], a[144:147], v[52:55], v[240:243]
  v_exp_f32_e64 v35, v35
  v_mfma_f32_16x16x32_bf16 v[244:247], a[148:151], v[52:55], v[244:247]
  v_cvt_pk_bf16_f32 v49, v34, v35
  ds_read_b64_tr_b16 a[166:167], v9 offset:20480
  v_mfma_f32_16x16x32_bf16 v[248:251], a[152:155], v[52:55], v[248:251]
  v_exp_f32_e64 v36, v36
  v_mfma_f32_16x16x32_bf16 v[252:255], a[156:159], v[52:55], v[252:255]
  ds_read_b64_tr_b16 a[168:169], v10 offset:16384
  v_mfma_f32_16x16x32_bf16 v[40:43], a[64:67], a[16:19], v[60:63]
  v_exp_f32_e64 v37, v37
  v_mfma_f32_16x16x32_bf16 v[40:43], a[68:71], a[20:23], v[40:43]
  v_cvt_pk_bf16_f32 v50, v36, v37
  v_mfma_f32_16x16x32_bf16 v[40:43], a[72:75], a[24:27], v[40:43]
  v_exp_f32_e64 v38, v38
  v_mfma_f32_16x16x32_bf16 v[40:43], a[76:79], a[28:31], v[40:43]
  ds_read_b64_tr_b16 a[170:171], v10 offset:20480
  v_mfma_f32_16x16x32_bf16 v[44:47], a[92:95], a[28:31], v[60:63]
  v_exp_f32_e64 v39, v39
  v_mfma_f32_16x16x32_bf16 v[44:47], a[88:91], a[24:27], v[44:47]
  v_cvt_pk_bf16_f32 v51, v38, v39
  ds_read_b64_tr_b16 a[172:173], v11 offset:16384
  v_mfma_f32_16x16x32_bf16 v[44:47], a[84:87], a[20:23], v[44:47]
  buffer_load_dwordx4 v21, s[12:15], s43 offen offset:3072 nt lds
  v_mfma_f32_16x16x32_bf16 v[44:47], a[80:83], a[16:19], v[44:47]
  v_exp_f32_e64 v40, v40
  v_mfma_f32_16x16x32_bf16 v[128:131], a[128:131], v[48:51], v[128:131]
  ds_read_b64_tr_b16 a[174:175], v11 offset:20480
  v_mfma_f32_16x16x32_bf16 v[132:135], a[132:135], v[48:51], v[132:135]
  v_exp_f32_e64 v41, v41
  v_mfma_f32_16x16x32_bf16 v[136:139], a[136:139], v[48:51], v[136:139]
  v_cvt_pk_bf16_f32 v52, v40, v41
  ds_read_b64_tr_b16 a[176:177], v12 offset:16384
  v_mfma_f32_16x16x32_bf16 v[140:143], a[140:143], v[48:51], v[140:143]
  v_exp_f32_e64 v42, v42
  v_mfma_f32_16x16x32_bf16 v[144:147], a[144:147], v[48:51], v[144:147]
  ds_read_b64_tr_b16 a[178:179], v12 offset:20480
  v_mfma_f32_16x16x32_bf16 v[148:151], a[148:151], v[48:51], v[148:151]
  v_exp_f32_e64 v43, v43
  v_mfma_f32_16x16x32_bf16 v[152:155], a[152:155], v[48:51], v[152:155]
  v_cvt_pk_bf16_f32 v53, v42, v43
  ds_read_b64_tr_b16 a[180:181], v13 offset:16384
  v_mfma_f32_16x16x32_bf16 v[156:159], a[156:159], v[48:51], v[156:159]
  s_waitcnt lgkmcnt(4)
  v_exp_f32 v44, v44
  v_mfma_f32_16x16x32_bf16 v[32:35], a[96:99], a[32:35], v[64:67]
  v_mfma_f32_16x16x32_bf16 v[32:35], a[100:103], a[36:39], v[32:35]
  v_exp_f32_e64 v45, v45
  v_mfma_f32_16x16x32_bf16 v[32:35], a[104:107], a[40:43], v[32:35]
  v_cvt_pk_bf16_f32 v54, v44, v45
  ds_read_b64_tr_b16 a[182:183], v13 offset:20480
  v_mfma_f32_16x16x32_bf16 v[32:35], a[108:111], a[44:47], v[32:35]
  s_sub_u32 s43, s43, s57
  v_exp_f32 v46, v46
  v_mfma_f32_16x16x32_bf16 v[36:39], a[124:127], a[44:47], v[64:67]
  ds_read_b64_tr_b16 a[184:185], v14 offset:16384
  v_mfma_f32_16x16x32_bf16 v[36:39], a[120:123], a[40:43], v[36:39]
  s_and_b32 s43, s43, s57
  v_exp_f32 v47, v47
  v_mfma_f32_16x16x32_bf16 v[36:39], a[116:119], a[36:39], v[36:39]
  v_cvt_pk_bf16_f32 v55, v46, v47
  ds_read_b64_tr_b16 a[186:187], v14 offset:20480
  v_mfma_f32_16x16x32_bf16 v[36:39], a[112:115], a[32:35], v[36:39]
  s_add_u32 m0, s41, 32768
  v_exp_f32_e64 v32, v32
  v_smfmac_f32_16x16x64_bf16 v[104:107], v[120:123], v[48:55], v78
  buffer_load_dwordx4 v16, s[8:11], s43 offen offset:0 nt lds
  ds_read_b64_tr_b16 a[188:189], v15 offset:16384
  v_mfma_f32_16x16x32_bf16 v[160:163], a[128:131], v[52:55], v[160:163]
  v_exp_f32_e64 v33, v33
  v_mfma_f32_16x16x32_bf16 v[164:167], a[132:135], v[52:55], v[164:167]
  v_cvt_pk_bf16_f32 v48, v32, v33
  v_mfma_f32_16x16x32_bf16 v[168:171], a[136:139], v[52:55], v[168:171]
  v_exp_f32_e64 v34, v34
  v_mfma_f32_16x16x32_bf16 v[172:175], a[140:143], v[52:55], v[172:175]
  ds_read_b64_tr_b16 a[190:191], v15 offset:20480
  v_mfma_f32_16x16x32_bf16 v[176:179], a[144:147], v[52:55], v[176:179]
  v_exp_f32_e64 v35, v35
  v_mfma_f32_16x16x32_bf16 v[180:183], a[148:151], v[52:55], v[180:183]
  v_cvt_pk_bf16_f32 v49, v34, v35
  v_mfma_f32_16x16x32_bf16 v[184:187], a[152:155], v[52:55], v[184:187]
  v_exp_f32_e64 v36, v36
  v_mfma_f32_16x16x32_bf16 v[188:191], a[156:159], v[52:55], v[188:191]
  buffer_load_dwordx4 v17, s[8:11], s43 offen offset:1024 nt lds
  v_mfma_f32_16x16x32_bf16 v[40:43], a[96:99], a[48:51], v[68:71]
  v_exp_f32_e64 v37, v37
  v_mfma_f32_16x16x32_bf16 v[40:43], a[100:103], a[52:55], v[40:43]
  v_cvt_pk_bf16_f32 v50, v36, v37
  v_mfma_f32_16x16x32_bf16 v[40:43], a[104:107], a[56:59], v[40:43]
  s_waitcnt vmcnt(10) lgkmcnt(0)
  v_exp_f32 v38, v38
  v_mfma_f32_16x16x32_bf16 v[40:43], a[108:111], a[60:63], v[40:43]
  s_barrier
  ds_read_b128 a[64:67], v4 offset:0
  v_mfma_f32_16x16x32_bf16 v[44:47], a[124:127], a[60:63], v[68:71]
  v_exp_f32 v39, v39
  v_mfma_f32_16x16x32_bf16 v[44:47], a[120:123], a[56:59], v[44:47]
  v_cvt_pk_bf16_f32 v51, v38, v39
  ds_read_b128 a[68:71], v5 offset:0
  v_mfma_f32_16x16x32_bf16 v[44:47], a[116:119], a[52:55], v[44:47]
  buffer_load_dwordx4 v18, s[8:11], s43 offen offset:2048 nt lds
  v_mfma_f32_16x16x32_bf16 v[44:47], a[112:115], a[48:51], v[44:47]
  v_exp_f32_e64 v40, v40
  v_mfma_f32_16x16x32_bf16 v[192:195], a[160:163], v[48:51], v[192:195]
  buffer_load_dwordx4 v19, s[8:11], s43 offen offset:3072 nt lds
  ds_read_b128 a[72:75], v6 offset:0
  v_mfma_f32_16x16x32_bf16 v[196:199], a[164:167], v[48:51], v[196:199]
  v_exp_f32_e64 v41, v41
  v_mfma_f32_16x16x32_bf16 v[200:203], a[168:171], v[48:51], v[200:203]
  v_cvt_pk_bf16_f32 v52, v40, v41
  ds_read_b128 a[76:79], v7 offset:0
  v_mfma_f32_16x16x32_bf16 v[204:207], a[172:175], v[48:51], v[204:207]
  v_exp_f32_e64 v42, v42
  v_mfma_f32_16x16x32_bf16 v[208:211], a[176:179], v[48:51], v[208:211]
  ds_read_b128 a[92:95], v7 offset:4096
  v_mfma_f32_16x16x32_bf16 v[212:215], a[180:183], v[48:51], v[212:215]
  v_exp_f32_e64 v43, v43
  v_mfma_f32_16x16x32_bf16 v[216:219], a[184:187], v[48:51], v[216:219]
  v_cvt_pk_bf16_f32 v53, v42, v43
  ds_read_b128 a[88:91], v6 offset:4096
  v_mfma_f32_16x16x32_bf16 v[220:223], a[188:191], v[48:51], v[220:223]
  s_add_u32 m0, s41, 65536
  v_exp_f32_e64 v44, v44
  v_mfma_f32_16x16x32_bf16 v[32:35], a[96:99], a[0:3], v[56:59]
  buffer_load_dwordx4 v20, s[12:15], s43 offen offset:0 nt lds
  v_mfma_f32_16x16x32_bf16 v[32:35], a[100:103], a[4:7], v[32:35]
  v_exp_f32_e64 v45, v45
  v_mfma_f32_16x16x32_bf16 v[32:35], a[104:107], a[8:11], v[32:35]
  v_cvt_pk_bf16_f32 v54, v44, v45
  ds_read_b128 a[84:87], v5 offset:4096
  v_mfma_f32_16x16x32_bf16 v[32:35], a[108:111], a[12:15], v[32:35]
  v_exp_f32_e64 v46, v46
  v_mfma_f32_16x16x32_bf16 v[36:39], a[124:127], a[12:15], v[56:59]
  ds_read_b128 a[80:83], v4 offset:4096
  v_mfma_f32_16x16x32_bf16 v[36:39], a[120:123], a[8:11], v[36:39]
  v_exp_f32_e64 v47, v47
  v_mfma_f32_16x16x32_bf16 v[36:39], a[116:119], a[4:7], v[36:39]
  v_cvt_pk_bf16_f32 v55, v46, v47
  ds_read_b64_tr_b16 a[128:129], v8 offset:32768
  v_mfma_f32_16x16x32_bf16 v[36:39], a[112:115], a[0:3], v[36:39]
  v_exp_f32_e64 v32, v32
  v_smfmac_f32_16x16x64_bf16 v[108:111], v[120:123], v[48:55], v78
  buffer_load_dwordx4 v21, s[12:15], s43 offen offset:1024 nt lds
  ds_read_b64_tr_b16 a[130:131], v8 offset:36864
  v_mfma_f32_16x16x32_bf16 v[224:227], a[160:163], v[52:55], v[224:227]
  v_exp_f32_e64 v33, v33
  v_mfma_f32_16x16x32_bf16 v[228:231], a[164:167], v[52:55], v[228:231]
  v_cvt_pk_bf16_f32 v48, v32, v33
  v_mfma_f32_16x16x32_bf16 v[232:235], a[168:171], v[52:55], v[232:235]
  v_exp_f32_e64 v34, v34
  v_mfma_f32_16x16x32_bf16 v[236:239], a[172:175], v[52:55], v[236:239]
  buffer_load_dwordx4 v20, s[12:15], s43 offen offset:2048 nt lds
  ds_read_b64_tr_b16 a[132:133], v9 offset:32768
  v_mfma_f32_16x16x32_bf16 v[240:243], a[176:179], v[52:55], v[240:243]
  v_exp_f32_e64 v35, v35
  v_mfma_f32_16x16x32_bf16 v[244:247], a[180:183], v[52:55], v[244:247]
  v_cvt_pk_bf16_f32 v49, v34, v35
  ds_read_b64_tr_b16 a[134:135], v9 offset:36864
  v_mfma_f32_16x16x32_bf16 v[248:251], a[184:187], v[52:55], v[248:251]
  v_exp_f32_e64 v36, v36
  v_mfma_f32_16x16x32_bf16 v[252:255], a[188:191], v[52:55], v[252:255]
  ds_read_b64_tr_b16 a[136:137], v10 offset:32768
  v_mfma_f32_16x16x32_bf16 v[40:43], a[96:99], a[16:19], v[60:63]
  v_exp_f32_e64 v37, v37
  v_mfma_f32_16x16x32_bf16 v[40:43], a[100:103], a[20:23], v[40:43]
  v_cvt_pk_bf16_f32 v50, v36, v37
  v_mfma_f32_16x16x32_bf16 v[40:43], a[104:107], a[24:27], v[40:43]
  v_exp_f32_e64 v38, v38
  v_mfma_f32_16x16x32_bf16 v[40:43], a[108:111], a[28:31], v[40:43]
  ds_read_b64_tr_b16 a[138:139], v10 offset:36864
  v_mfma_f32_16x16x32_bf16 v[44:47], a[124:127], a[28:31], v[60:63]
  v_exp_f32_e64 v39, v39
  v_mfma_f32_16x16x32_bf16 v[44:47], a[120:123], a[24:27], v[44:47]
  v_cvt_pk_bf16_f32 v51, v38, v39
  ds_read_b64_tr_b16 a[140:141], v11 offset:32768
  v_mfma_f32_16x16x32_bf16 v[44:47], a[116:119], a[20:23], v[44:47]
  buffer_load_dwordx4 v21, s[12:15], s43 offen offset:3072 nt lds
  v_mfma_f32_16x16x32_bf16 v[44:47], a[112:115], a[16:19], v[44:47]
  v_exp_f32_e64 v40, v40
  v_mfma_f32_16x16x32_bf16 v[128:131], a[160:163], v[48:51], v[128:131]
  ds_read_b64_tr_b16 a[142:143], v11 offset:36864
  v_mfma_f32_16x16x32_bf16 v[132:135], a[164:167], v[48:51], v[132:135]
  v_exp_f32_e64 v41, v41
  v_mfma_f32_16x16x32_bf16 v[136:139], a[168:171], v[48:51], v[136:139]
  v_cvt_pk_bf16_f32 v52, v40, v41
  ds_read_b64_tr_b16 a[144:145], v12 offset:32768
  v_mfma_f32_16x16x32_bf16 v[140:143], a[172:175], v[48:51], v[140:143]
  v_exp_f32_e64 v42, v42
  v_mfma_f32_16x16x32_bf16 v[144:147], a[176:179], v[48:51], v[144:147]
  ds_read_b64_tr_b16 a[146:147], v12 offset:36864
  v_mfma_f32_16x16x32_bf16 v[148:151], a[180:183], v[48:51], v[148:151]
  v_exp_f32_e64 v43, v43
  v_mfma_f32_16x16x32_bf16 v[152:155], a[184:187], v[48:51], v[152:155]
L_w4:
  s_cbranch_execz L_wdone
  v_cvt_pk_bf16_f32 v53, v42, v43
  ds_read_b64_tr_b16 a[148:149], v13 offset:32768
  v_mfma_f32_16x16x32_bf16 v[156:159], a[188:191], v[48:51], v[156:159]
  s_waitcnt lgkmcnt(4)
  v_exp_f32_e64 v44, v44
  v_mfma_f32_16x16x32_bf16 v[32:35], a[64:67], a[32:35], v[64:67]
  v_mfma_f32_16x16x32_bf16 v[32:35], a[68:71], a[36:39], v[32:35]
  v_exp_f32_e64 v45, v45
  v_mfma_f32_16x16x32_bf16 v[32:35], a[72:75], a[40:43], v[32:35]
  v_cvt_pk_bf16_f32 v54, v44, v45
  ds_read_b64_tr_b16 a[150:151], v13 offset:36864
  v_mfma_f32_16x16x32_bf16 v[32:35], a[76:79], a[44:47], v[32:35]
  s_sub_u32 s43, s43, s57
  v_exp_f32 v46, v46
  v_mfma_f32_16x16x32_bf16 v[36:39], a[92:95], a[44:47], v[64:67]
  ds_read_b64_tr_b16 a[152:153], v14 offset:32768
  v_mfma_f32_16x16x32_bf16 v[36:39], a[88:91], a[40:43], v[36:39]
  s_and_b32 s43, s43, s57
  v_exp_f32 v47, v47
  v_mfma_f32_16x16x32_bf16 v[36:39], a[84:87], a[36:39], v[36:39]
  v_cvt_pk_bf16_f32 v55, v46, v47
  ds_read_b64_tr_b16 a[154:155], v14 offset:36864
  v_mfma_f32_16x16x32_bf16 v[36:39], a[80:83], a[32:35], v[36:39]
  s_add_u32 m0, s41, 49152
  v_exp_f32_e64 v32, v32
  v_smfmac_f32_16x16x64_bf16 v[104:107], v[120:123], v[48:55], v78
  buffer_load_dwordx4 v16, s[8:11], s43 offen offset:0 nt lds
  ds_read_b64_tr_b16 a[156:157], v15 offset:32768
  v_mfma_f32_16x16x32_bf16 v[160:163], a[160:163], v[52:55], v[160:163]
  v_exp_f32_e64 v33, v33
  v_mfma_f32_16x16x32_bf16 v[164:167], a[164:167], v[52:55], v[164:167]
  v_cvt_pk_bf16_f32 v48, v32, v33
  v_mfma_f32_16x16x32_bf16 v[168:171], a[168:171], v[52:55], v[168:171]
  v_exp_f32_e64 v34, v34
  v_mfma_f32_16x16x32_bf16 v[172:175], a[172:175], v[52:55], v[172:175]
  ds_read_b64_tr_b16 a[158:159], v15 offset:36864
  v_mfma_f32_16x16x32_bf16 v[176:179], a[176:179], v[52:55], v[176:179]
  v_exp_f32_e64 v35, v35
  v_mfma_f32_16x16x32_bf16 v[180:183], a[180:183], v[52:55], v[180:183]
  v_cvt_pk_bf16_f32 v49, v34, v35
  v_mfma_f32_16x16x32_bf16 v[184:187], a[184:187], v[52:55], v[184:187]
  v_exp_f32_e64 v36, v36
  v_mfma_f32_16x16x32_bf16 v[188:191], a[188:191], v[52:55], v[188:191]
  buffer_load_dwordx4 v17, s[8:11], s43 offen offset:1024 nt lds
  v_mfma_f32_16x16x32_bf16 v[40:43], a[64:67], a[48:51], v[68:71]
  v_exp_f32_e64 v37, v37
  v_mfma_f32_16x16x32_bf16 v[40:43], a[68:71], a[52:55], v[40:43]
  buffer_load_dwordx4 v18, s[8:11], s43 offen offset:2048 nt lds
  v_cvt_pk_bf16_f32 v50, v36, v37
  v_mfma_f32_16x16x32_bf16 v[40:43], a[72:75], a[56:59], v[40:43]
  s_waitcnt vmcnt(11) lgkmcnt(0)
  v_exp_f32 v38, v38
  v_mfma_f32_16x16x32_bf16 v[40:43], a[76:79], a[60:63], v[40:43]
  s_barrier
  ds_read_b128 a[96:99], v4 offset:16384
  v_mfma_f32_16x16x32_bf16 v[44:47], a[92:95], a[60:63], v[68:71]
  s_load_dword s65, s[32:33], s64
  v_exp_f32 v39, v39
  v_mfma_f32_16x16x32_bf16 v[44:47], a[88:91], a[56:59], v[44:47]
  v_cvt_pk_bf16_f32 v51, v38, v39
  ds_read_b128 a[100:103], v5 offset:16384
  v_mfma_f32_16x16x32_bf16 v[44:47], a[84:87], a[52:55], v[44:47]
  ds_read_b128 a[104:107], v6 offset:16384
  v_mfma_f32_16x16x32_bf16 v[44:47], a[80:83], a[48:51], v[44:47]
  v_exp_f32_e64 v40, v40
  v_mfma_f32_16x16x32_bf16 v[192:195], a[128:131], v[48:51], v[192:195]
  buffer_load_dwordx4 v19, s[8:11], s43 offen offset:3072 nt lds
  v_mfma_f32_16x16x32_bf16 v[196:199], a[132:135], v[48:51], v[196:199]
  v_exp_f32_e64 v41, v41
  v_mfma_f32_16x16x32_bf16 v[200:203], a[136:139], v[48:51], v[200:203]
  v_cvt_pk_bf16_f32 v52, v40, v41
  ds_read_b128 a[108:111], v7 offset:16384
  v_mfma_f32_16x16x32_bf16 v[204:207], a[140:143], v[48:51], v[204:207]
  v_exp_f32_e64 v42, v42
  v_mfma_f32_16x16x32_bf16 v[208:211], a[144:147], v[48:51], v[208:211]
  ds_read_b128 a[124:127], v7 offset:20480
  v_mfma_f32_16x16x32_bf16 v[212:215], a[148:151], v[48:51], v[212:215]
  v_exp_f32_e64 v43, v43
  v_mfma_f32_16x16x32_bf16 v[216:219], a[152:155], v[48:51], v[216:219]
  v_cvt_pk_bf16_f32 v53, v42, v43
  ds_read_b128 a[120:123], v6 offset:20480
  v_mfma_f32_16x16x32_bf16 v[220:223], a[156:159], v[48:51], v[220:223]
  v_exp_f32_e64 v44, v44
  v_mfma_f32_16x16x32_bf16 v[32:35], a[64:67], a[0:3], v[56:59]
  ds_read_b128 a[116:119], v5 offset:20480
  v_mfma_f32_16x16x32_bf16 v[32:35], a[68:71], a[4:7], v[32:35]
  v_exp_f32_e64 v45, v45
  v_mfma_f32_16x16x32_bf16 v[32:35], a[72:75], a[8:11], v[32:35]
  v_cvt_pk_bf16_f32 v54, v44, v45
  ds_read_b128 a[112:115], v4 offset:20480
  v_mfma_f32_16x16x32_bf16 v[32:35], a[76:79], a[12:15], v[32:35]
  s_add_u32 m0, s41, 81920
  v_exp_f32_e64 v46, v46
  v_mfma_f32_16x16x32_bf16 v[36:39], a[92:95], a[12:15], v[56:59]
  buffer_load_dwordx4 v20, s[12:15], s43 offen offset:0 nt lds
  v_mfma_f32_16x16x32_bf16 v[36:39], a[88:91], a[8:11], v[36:39]
  v_exp_f32_e64 v47, v47
  v_mfma_f32_16x16x32_bf16 v[36:39], a[84:87], a[4:7], v[36:39]
  v_cvt_pk_bf16_f32 v55, v46, v47
  ds_read_b64_tr_b16 a[160:161], v8 offset:49152
  v_mfma_f32_16x16x32_bf16 v[36:39], a[80:83], a[0:3], v[36:39]
  v_exp_f32_e64 v32, v32
  v_smfmac_f32_16x16x64_bf16 v[108:111], v[120:123], v[48:55], v78
  buffer_load_dwordx4 v21, s[12:15], s43 offen offset:1024 nt lds
  ds_read_b64_tr_b16 a[162:163], v8 offset:53248
  v_mfma_f32_16x16x32_bf16 v[224:227], a[128:131], v[52:55], v[224:227]
  v_exp_f32_e64 v33, v33
  v_mfma_f32_16x16x32_bf16 v[228:231], a[132:135], v[52:55], v[228:231]
  v_cvt_pk_bf16_f32 v48, v32, v33
  ds_read_b64_tr_b16 a[164:165], v9 offset:49152
  v_mfma_f32_16x16x32_bf16 v[232:235], a[136:139], v[52:55], v[232:235]
  v_exp_f32_e64 v34, v34
  v_mfma_f32_16x16x32_bf16 v[236:239], a[140:143], v[52:55], v[236:239]
  buffer_load_dwordx4 v20, s[12:15], s43 offen offset:2048 nt lds
  ds_read_b64_tr_b16 a[166:167], v9 offset:53248
  v_mfma_f32_16x16x32_bf16 v[240:243], a[144:147], v[52:55], v[240:243]
  v_exp_f32_e64 v35, v35
  v_mfma_f32_16x16x32_bf16 v[244:247], a[148:151], v[52:55], v[244:247]
  v_cvt_pk_bf16_f32 v49, v34, v35
  ds_read_b64_tr_b16 a[168:169], v10 offset:49152
  v_mfma_f32_16x16x32_bf16 v[248:251], a[152:155], v[52:55], v[248:251]
  v_exp_f32_e64 v36, v36
  v_mfma_f32_16x16x32_bf16 v[252:255], a[156:159], v[52:55], v[252:255]
  ds_read_b64_tr_b16 a[170:171], v10 offset:53248
  v_mfma_f32_16x16x32_bf16 v[40:43], a[64:67], a[16:19], v[60:63]
  v_exp_f32_e64 v37, v37
  v_mfma_f32_16x16x32_bf16 v[40:43], a[68:71], a[20:23], v[40:43]
  v_cvt_pk_bf16_f32 v50, v36, v37
  v_mfma_f32_16x16x32_bf16 v[40:43], a[72:75], a[24:27], v[40:43]
  v_exp_f32_e64 v38, v38
  v_mfma_f32_16x16x32_bf16 v[40:43], a[76:79], a[28:31], v[40:43]
  ds_read_b64_tr_b16 a[172:173], v11 offset:49152
  v_mfma_f32_16x16x32_bf16 v[44:47], a[92:95], a[28:31], v[60:63]
  v_exp_f32_e64 v39, v39
  v_mfma_f32_16x16x32_bf16 v[44:47], a[88:91], a[24:27], v[44:47]
  v_cvt_pk_bf16_f32 v51, v38, v39
  ds_read_b64_tr_b16 a[174:175], v11 offset:53248
  v_mfma_f32_16x16x32_bf16 v[44:47], a[84:87], a[20:23], v[44:47]
  buffer_load_dwordx4 v21, s[12:15], s43 offen offset:3072 nt lds
  v_mfma_f32_16x16x32_bf16 v[44:47], a[80:83], a[16:19], v[44:47]
  v_exp_f32_e64 v40, v40
  v_mfma_f32_16x16x32_bf16 v[128:131], a[128:131], v[48:51], v[128:131]
  ds_read_b64_tr_b16 a[176:177], v12 offset:49152
  v_mfma_f32_16x16x32_bf16 v[132:135], a[132:135], v[48:51], v[132:135]
  v_exp_f32_e64 v41, v41
  v_mfma_f32_16x16x32_bf16 v[136:139], a[136:139], v[48:51], v[136:139]
  v_cvt_pk_bf16_f32 v52, v40, v41
  ds_read_b64_tr_b16 a[178:179], v12 offset:53248
  v_mfma_f32_16x16x32_bf16 v[140:143], a[140:143], v[48:51], v[140:143]
  v_exp_f32_e64 v42, v42
  v_mfma_f32_16x16x32_bf16 v[144:147], a[144:147], v[48:51], v[144:147]
  ds_read_b64_tr_b16 a[180:181], v13 offset:49152
  v_mfma_f32_16x16x32_bf16 v[148:151], a[148:151], v[48:51], v[148:151]
  v_exp_f32_e64 v43, v43
  v_mfma_f32_16x16x32_bf16 v[152:155], a[152:155], v[48:51], v[152:155]
  v_cvt_pk_bf16_f32 v53, v42, v43
  ds_read_b64_tr_b16 a[182:183], v13 offset:53248
  v_mfma_f32_16x16x32_bf16 v[156:159], a[156:159], v[48:51], v[156:159]
  s_waitcnt lgkmcnt(4)
  v_exp_f32 v44, v44
  v_mfma_f32_16x16x32_bf16 v[32:35], a[96:99], a[32:35], v[64:67]
  ds_read_b64_tr_b16 a[184:185], v14 offset:49152
  v_mfma_f32_16x16x32_bf16 v[32:35], a[100:103], a[36:39], v[32:35]
  v_exp_f32_e64 v45, v45
  v_mfma_f32_16x16x32_bf16 v[32:35], a[104:107], a[40:43], v[32:35]
  s_xor_b32 s63, s52, 0
  v_cvt_pk_bf16_f32 v54, v44, v45
  ds_read_b64_tr_b16 a[186:187], v14 offset:53248
  v_mfma_f32_16x16x32_bf16 v[32:35], a[108:111], a[44:47], v[32:35]
  s_add_u32 m0, s41, 131072
  v_exp_f32 v46, v46
  v_mfma_f32_16x16x32_bf16 v[36:39], a[124:127], a[44:47], v[64:67]
  buffer_load_dwordx4 v80, s[20:23], s63 offen offset:0  lds
  v_mfma_f32_16x16x32_bf16 v[36:39], a[120:123], a[40:43], v[36:39]
  v_exp_f32_e64 v47, v47
  v_mfma_f32_16x16x32_bf16 v[36:39], a[116:119], a[36:39], v[36:39]
  v_cvt_pk_bf16_f32 v55, v46, v47
  ds_read_b64_tr_b16 a[188:189], v15 offset:49152
  v_mfma_f32_16x16x32_bf16 v[36:39], a[112:115], a[32:35], v[36:39]
  v_exp_f32_e64 v32, v32
  v_smfmac_f32_16x16x64_bf16 v[104:107], v[120:123], v[48:55], v78
  ds_read_b64_tr_b16 a[190:191], v15 offset:53248
  v_mfma_f32_16x16x32_bf16 v[160:163], a[128:131], v[52:55], v[160:163]
  v_exp_f32_e64 v33, v33
  v_mfma_f32_16x16x32_bf16 v[164:167], a[132:135], v[52:55], v[164:167]
  v_cvt_pk_bf16_f32 v48, v32, v33
  v_mfma_f32_16x16x32_bf16 v[168:171], a[136:139], v[52:55], v[168:171]
  v_exp_f32_e64 v34, v34
  v_mfma_f32_16x16x32_bf16 v[172:175], a[140:143], v[52:55], v[172:175]
  buffer_load_dwordx4 v81, s[20:23], s63 offen offset:1024  lds
  v_mfma_f32_16x16x32_bf16 v[176:179], a[144:147], v[52:55], v[176:179]
  v_exp_f32_e64 v35, v35
  v_mfma_f32_16x16x32_bf16 v[180:183], a[148:151], v[52:55], v[180:183]
  v_cvt_pk_bf16_f32 v49, v34, v35
  v_mfma_f32_16x16x32_bf16 v[184:187], a[152:155], v[52:55], v[184:187]
  s_waitcnt vmcnt(10) lgkmcnt(0)
  v_exp_f32 v36, v36
  v_mfma_f32_16x16x32_bf16 v[188:191], a[156:159], v[52:55], v[188:191]
  s_barrier
  ds_read_b128 a[64:67], v4 offset:32768
  v_mfma_f32_16x16x32_bf16 v[40:43], a[96:99], a[48:51], v[68:71]
  s_and_b32 s47, s65, 0xfff0
  s_cbranch_scc0 L_rG
L_rG_b:
  v_exp_f32_e64 v37, v37
  v_mfma_f32_16x16x32_bf16 v[40:43], a[100:103], a[52:55], v[40:43]
  s_and_b32 s47, s65, 0x3fff
  v_cvt_pk_bf16_f32 v50, v36, v37
  ds_read_b128 a[68:71], v5 offset:32768
  v_mfma_f32_16x16x32_bf16 v[40:43], a[104:107], a[56:59], v[40:43]
  s_mul_i32 s47, s47, 3
  v_exp_f32 v38, v38
  v_mfma_f32_16x16x32_bf16 v[40:43], a[108:111], a[60:63], v[40:43]
  s_lshr_b32 s65, s65, 14
  buffer_load_dwordx4 v82, s[20:23], s63 offen offset:2048  lds
  ds_read_b128 a[72:75], v6 offset:32768
  v_mfma_f32_16x16x32_bf16 v[44:47], a[124:127], a[60:63], v[68:71]
  s_cmp_ge_u32 s65, s47
  s_cselect_b32 s37, 0x2000, 0
  s_cselect_b32 s93, s3, s93
  v_exp_f32 v39, v39
  v_mfma_f32_16x16x32_bf16 v[44:47], a[120:123], a[56:59], v[44:47]
  s_xor_b32 s92, s92, s37
  v_cvt_pk_bf16_f32 v51, v38, v39
  ds_read_b128 a[76:79], v7 offset:32768
  v_mfma_f32_16x16x32_bf16 v[44:47], a[116:119], a[52:55], v[44:47]
  s_xor_b32 s51, s51, s37
  ds_read_b128 a[92:95], v7 offset:36864
  v_mfma_f32_16x16x32_bf16 v[44:47], a[112:115], a[48:51], v[44:47]
  v_exp_f32_e64 v40, v40
  v_mfma_f32_16x16x32_bf16 v[192:195], a[160:163], v[48:51], v[192:195]
  buffer_load_dwordx4 v83, s[20:23], s63 offen offset:3072  lds
  v_xor_b32_e64 v28, s37, v28
  v_mfma_f32_16x16x32_bf16 v[196:199], a[164:167], v[48:51], v[196:199]
  v_exp_f32_e64 v41, v41
  v_mfma_f32_16x16x32_bf16 v[200:203], a[168:171], v[48:51], v[200:203]
  v_cvt_pk_bf16_f32 v52, v40, v41
  v_xor_b32_e64 v30, s37, v30
  v_mfma_f32_16x16x32_bf16 v[204:207], a[172:175], v[48:51], v[204:207]
  s_xor_b32 s47, s51, 0x2000
  v_exp_f32_e64 v42, v42
  v_mfma_f32_16x16x32_bf16 v[208:211], a[176:179], v[48:51], v[208:211]
  buffer_load_dword v75, off, s[24:27], s47
  ds_read_b128 a[88:91], v6 offset:36864
  v_mfma_f32_16x16x32_bf16 v[212:215], a[180:183], v[48:51], v[212:215]
  v_exp_f32_e64 v43, v43
  v_mfma_f32_16x16x32_bf16 v[216:219], a[184:187], v[48:51], v[216:219]
  s_xor_b32 s63, s52, 65536
  v_cvt_pk_bf16_f32 v53, v42, v43
  ds_read_b128 a[84:87], v5 offset:36864
  v_mfma_f32_16x16x32_bf16 v[220:223], a[188:191], v[48:51], v[220:223]
  s_add_u32 m0, s41, 147456
  v_exp_f32_e64 v44, v44
  v_mfma_f32_16x16x32_bf16 v[32:35], a[96:99], a[0:3], v[56:59]
  buffer_load_dwordx4 v80, s[20:23], s63 offen offset:0  lds
  ds_read_b128 a[80:83], v4 offset:36864
  v_mfma_f32_16x16x32_bf16 v[32:35], a[100:103], a[4:7], v[32:35]
  v_exp_f32_e64 v45, v45
  v_mfma_f32_16x16x32_bf16 v[32:35], a[104:107], a[8:11], v[32:35]
  v_cvt_pk_bf16_f32 v54, v44, v45
  ds_read_b64_tr_b16 a[128:129], v8 offset:0
  v_mfma_f32_16x16x32_bf16 v[32:35], a[108:111], a[12:15], v[32:35]
  v_exp_f32_e64 v46, v46
  v_mfma_f32_16x16x32_bf16 v[36:39], a[124:127], a[12:15], v[56:59]
  ds_read_b64_tr_b16 a[130:131], v8 offset:4096
  v_mfma_f32_16x16x32_bf16 v[36:39], a[120:123], a[8:11], v[36:39]
  v_exp_f32_e64 v47, v47
  v_mfma_f32_16x16x32_bf16 v[36:39], a[116:119], a[4:7], v[36:39]
  v_cvt_pk_bf16_f32 v55, v46, v47
  ds_read_b64_tr_b16 a[132:133], v9 offset:0
  v_mfma_f32_16x16x32_bf16 v[36:39], a[112:115], a[0:3], v[36:39]
  v_exp_f32_e64 v32, v32
  v_smfmac_f32_16x16x64_bf16 v[108:111], v[120:123], v[48:55], v78
  buffer_load_dwordx4 v81, s[20:23], s63 offen offset:1024  lds
  ds_read_b64_tr_b16 a[134:135], v9 offset:4096
  v_mfma_f32_16x16x32_bf16 v[224:227], a[160:163], v[52:55], v[224:227]
  v_exp_f32_e64 v33, v33
  v_mfma_f32_16x16x32_bf16 v[228:231], a[164:167], v[52:55], v[228:231]
  v_cvt_pk_bf16_f32 v48, v32, v33
  ds_read_b64_tr_b16 a[136:137], v10 offset:0
  v_mfma_f32_16x16x32_bf16 v[232:235], a[168:171], v[52:55], v[232:235]
  v_exp_f32_e64 v34, v34
  v_mfma_f32_16x16x32_bf16 v[236:239], a[172:175], v[52:55], v[236:239]
  buffer_load_dwordx4 v82, s[20:23], s63 offen offset:2048  lds
  ds_read_b64_tr_b16 a[138:139], v10 offset:4096
  v_mfma_f32_16x16x32_bf16 v[240:243], a[176:179], v[52:55], v[240:243]
  v_exp_f32_e64 v35, v35
  v_mfma_f32_16x16x32_bf16 v[244:247], a[180:183], v[52:55], v[244:247]
  v_cvt_pk_bf16_f32 v49, v34, v35
  ds_read_b64_tr_b16 a[140:141], v11 offset:0
  v_mfma_f32_16x16x32_bf16 v[248:251], a[184:187], v[52:55], v[248:251]
  v_exp_f32_e64 v36, v36
  v_mfma_f32_16x16x32_bf16 v[252:255], a[188:191], v[52:55], v[252:255]
  ds_read_b64_tr_b16 a[142:143], v11 offset:4096
  v_mfma_f32_16x16x32_bf16 v[40:43], a[96:99], a[16:19], v[60:63]
  v_exp_f32_e64 v37, v37
  v_mfma_f32_16x16x32_bf16 v[40:43], a[100:103], a[20:23], v[40:43]
  v_cvt_pk_bf16_f32 v50, v36, v37
  ds_read_b64_tr_b16 a[144:145], v12 offset:0
  v_mfma_f32_16x16x32_bf16 v[40:43], a[104:107], a[24:27], v[40:43]
  v_exp_f32_e64 v38, v38
  v_mfma_f32_16x16x32_bf16 v[40:43], a[108:111], a[28:31], v[40:43]
  ds_read_b64_tr_b16 a[146:147], v12 offset:4096
  v_mfma_f32_16x16x32_bf16 v[44:47], a[124:127], a[28:31], v[60:63]
  v_exp_f32_e64 v39, v39
  v_mfma_f32_16x16x32_bf16 v[44:47], a[120:123], a[24:27], v[44:47]
  v_cvt_pk_bf16_f32 v51, v38, v39
  ds_read_b64_tr_b16 a[148:149], v13 offset:0
  v_mfma_f32_16x16x32_bf16 v[44:47], a[116:119], a[20:23], v[44:47]
  ds_read_b64_tr_b16 a[150:151], v13 offset:4096
  v_mfma_f32_16x16x32_bf16 v[44:47], a[112:115], a[16:19], v[44:47]
  v_exp_f32_e64 v40, v40
  v_mfma_f32_16x16x32_bf16 v[128:131], a[160:163], v[48:51], v[128:131]
  buffer_load_dwordx4 v83, s[20:23], s63 offen offset:3072  lds
  v_mfma_f32_16x16x32_bf16 v[132:135], a[164:167], v[48:51], v[132:135]
  v_exp_f32_e64 v41, v41
  v_mfma_f32_16x16x32_bf16 v[136:139], a[168:171], v[48:51], v[136:139]
  v_cvt_pk_bf16_f32 v52, v40, v41
  ds_read_b64_tr_b16 a[152:153], v14 offset:0
  v_mfma_f32_16x16x32_bf16 v[140:143], a[172:175], v[48:51], v[140:143]
  v_exp_f32_e64 v42, v42
  v_mfma_f32_16x16x32_bf16 v[144:147], a[176:179], v[48:51], v[144:147]
  ds_read_b64_tr_b16 a[154:155], v14 offset:4096
  v_mfma_f32_16x16x32_bf16 v[148:151], a[180:183], v[48:51], v[148:151]
  v_exp_f32_e64 v43, v43
  v_mfma_f32_16x16x32_bf16 v[152:155], a[184:187], v[48:51], v[152:155]
  v_cvt_pk_bf16_f32 v53, v42, v43
  ds_read_b64_tr_b16 a[156:157], v15 offset:0
  v_mfma_f32_16x16x32_bf16 v[156:159], a[188:191], v[48:51], v[156:159]
  s_waitcnt lgkmcnt(3)
  v_exp_f32 v44, v44
  v_mfma_f32_16x16x32_bf16 v[32:35], a[64:67], a[32:35], v[64:67]
  ds_read_b64_tr_b16 a[158:159], v15 offset:4096
  v_mfma_f32_16x16x32_bf16 v[32:35], a[68:71], a[36:39], v[32:35]
  v_exp_f32_e64 v45, v45
  v_mfma_f32_16x16x32_bf16 v[32:35], a[72:75], a[40:43], v[32:35]
  s_xor_b32 s63, s52, 131072
  v_cvt_pk_bf16_f32 v54, v44, v45
  v_mfma_f32_16x16x32_bf16 v[32:35], a[76:79], a[44:47], v[32:35]
  s_add_u32 m0, s41, 0
  v_exp_f32 v46, v46
  v_mfma_f32_16x16x32_bf16 v[36:39], a[92:95], a[44:47], v[64:67]
  buffer_load_dwordx4 v80, s[20:23], s63 offen offset:0  lds
  v_mfma_f32_16x16x32_bf16 v[36:39], a[88:91], a[40:43], v[36:39]
  v_exp_f32_e64 v47, v47
  v_mfma_f32_16x16x32_bf16 v[36:39], a[84:87], a[36:39], v[36:39]
  v_cvt_pk_bf16_f32 v55, v46, v47
  v_mfma_f32_16x16x32_bf16 v[36:39], a[80:83], a[32:35], v[36:39]
  s_waitcnt vmcnt(10) lgkmcnt(0)
  v_exp_f32 v32, v32
  v_smfmac_f32_16x16x64_bf16 v[104:107], v[120:123], v[48:55], v78
  s_barrier
  ds_read_b128 a[96:99], v4 offset:49152
  v_mfma_f32_16x16x32_bf16 v[160:163], a[160:163], v[52:55], v[160:163]
  v_exp_f32 v33, v33
  v_mfma_f32_16x16x32_bf16 v[164:167], a[164:167], v[52:55], v[164:167]
  ds_read_b128 a[100:103], v5 offset:49152
  v_cvt_pk_bf16_f32 v48, v32, v33
  v_mfma_f32_16x16x32_bf16 v[168:171], a[168:171], v[52:55], v[168:171]
  v_exp_f32_e64 v34, v34
  v_mfma_f32_16x16x32_bf16 v[172:175], a[172:175], v[52:55], v[172:175]
  ds_read_b128 a[104:107], v6 offset:49152
  buffer_load_dwordx4 v81, s[20:23], s63 offen offset:1024  lds
  v_mfma_f32_16x16x32_bf16 v[176:179], a[176:179], v[52:55], v[176:179]
  v_exp_f32_e64 v35, v35
  v_mfma_f32_16x16x32_bf16 v[180:183], a[180:183], v[52:55], v[180:183]
  ds_read_b128 a[108:111], v7 offset:49152
  v_cvt_pk_bf16_f32 v49, v34, v35
  v_mfma_f32_16x16x32_bf16 v[184:187], a[184:187], v[52:55], v[184:187]
  v_exp_f32_e64 v36, v36
  v_mfma_f32_16x16x32_bf16 v[188:191], a[188:191], v[52:55], v[188:191]
  ds_read_b128 a[124:127], v7 offset:53248
  buffer_load_dwordx4 v82, s[20:23], s63 offen offset:2048  lds
  v_mfma_f32_16x16x32_bf16 v[40:43], a[64:67], a[48:51], v[68:71]
  v_exp_f32_e64 v37, v37
  v_mfma_f32_16x16x32_bf16 v[40:43], a[68:71], a[52:55], v[40:43]
  ds_read_b128 a[120:123], v6 offset:53248
  v_cvt_pk_bf16_f32 v50, v36, v37
  v_mfma_f32_16x16x32_bf16 v[40:43], a[72:75], a[56:59], v[40:43]
  v_exp_f32_e64 v38, v38
  v_mfma_f32_16x16x32_bf16 v[40:43], a[76:79], a[60:63], v[40:43]
  ds_read_b128 a[116:119], v5 offset:53248
  v_mfma_f32_16x16x32_bf16 v[44:47], a[92:95], a[60:63], v[68:71]
  v_exp_f32_e64 v39, v39
  v_mfma_f32_16x16x32_bf16 v[44:47], a[88:91], a[56:59], v[44:47]
  ds_read_b128 a[112:115], v4 offset:53248
  v_cvt_pk_bf16_f32 v51, v38, v39
  v_mfma_f32_16x16x32_bf16 v[44:47], a[84:87], a[52:55], v[44:47]
  ds_read_b64_tr_b16 a[160:161], v8 offset:16384
  buffer_load_dwordx4 v83, s[20:23], s63 offen offset:3072  lds
  v_mfma_f32_16x16x32_bf16 v[44:47], a[80:83], a[48:51], v[44:47]
  v_exp_f32_e64 v40, v40
  v_mfma_f32_16x16x32_bf16 v[192:195], a[128:131], v[48:51], v[192:195]
  ds_read_b64_tr_b16 a[162:163], v8 offset:20480
  v_mfma_f32_16x16x32_bf16 v[196:199], a[132:135], v[48:51], v[196:199]
  v_exp_f32_e64 v41, v41
  v_mfma_f32_16x16x32_bf16 v[200:203], a[136:139], v[48:51], v[200:203]
  s_xor_b32 s63, s52, 196608
  ds_read_b64_tr_b16 a[164:165], v9 offset:16384
  v_cvt_pk_bf16_f32 v52, v40, v41
  v_mfma_f32_16x16x32_bf16 v[204:207], a[140:143], v[48:51], v[204:207]
  s_add_u32 m0, s41, 98304
  v_exp_f32_e64 v42, v42
  v_mfma_f32_16x16x32_bf16 v[208:211], a[144:147], v[48:51], v[208:211]
  ds_read_b64_tr_b16 a[166:167], v9 offset:20480
  buffer_load_dwordx4 v80, s[20:23], s63 offen offset:0  lds
  v_mfma_f32_16x16x32_bf16 v[212:215], a[148:151], v[48:51], v[212:215]
  v_exp_f32_e64 v43, v43
  v_mfma_f32_16x16x32_bf16 v[216:219], a[152:155], v[48:51], v[216:219]
  ds_read_b64_tr_b16 a[168:169], v10 offset:16384
  v_cvt_pk_bf16_f32 v53, v42, v43
  v_mfma_f32_16x16x32_bf16 v[220:223], a[156:159], v[48:51], v[220:223]
  s_waitcnt lgkmcnt(4)
  v_exp_f32 v44, v44
  v_mfma_f32_16x16x32_bf16 v[32:35], a[96:99], a[32:35], v[64:67]
  ds_read_b64_tr_b16 a[170:171], v10 offset:20480
  v_mfma_f32_16x16x32_bf16 v[32:35], a[100:103], a[36:39], v[32:35]
  v_exp_f32_e64 v45, v45
  v_mfma_f32_16x16x32_bf16 v[32:35], a[104:107], a[40:43], v[32:35]
  ds_read_b64_tr_b16 a[172:173], v11 offset:16384
  v_cvt_pk_bf16_f32 v54, v44, v45
  v_mfma_f32_16x16x32_bf16 v[32:35], a[108:111], a[44:47], v[32:35]
  v_exp_f32_e64 v46, v46
  v_mfma_f32_16x16x32_bf16 v[36:39], a[124:127], a[44:47], v[64:67]
  ds_read_b64_tr_b16 a[174:175], v11 offset:20480
  buffer_load_dwordx4 v81, s[20:23], s63 offen offset:1024  lds
  v_mfma_f32_16x16x32_bf16 v[36:39], a[120:123], a[40:43], v[36:39]
  v_exp_f32_e64 v47, v47
  v_mfma_f32_16x16x32_bf16 v[36:39], a[116:119], a[36:39], v[36:39]
  ds_read_b64_tr_b16 a[176:177], v12 offset:16384
  v_cvt_pk_bf16_f32 v55, v46, v47
  v_mfma_f32_16x16x32_bf16 v[36:39], a[112:115], a[32:35], v[36:39]
  v_exp_f32_e64 v32, v32
  v_smfmac_f32_16x16x64_bf16 v[108:111], v[120:123], v[48:55], v78
  ds_read_b64_tr_b16 a[178:179], v12 offset:20480
  buffer_load_dwordx4 v82, s[20:23], s63 offen offset:2048  lds
  v_mfma_f32_16x16x32_bf16 v[224:227], a[128:131], v[52:55], v[224:227]
  v_exp_f32_e64 v33, v33
  v_mfma_f32_16x16x32_bf16 v[228:231], a[132:135], v[52:55], v[228:231]
  ds_read_b64_tr_b16 a[180:181], v13 offset:16384
  v_cvt_pk_bf16_f32 v48, v32, v33
  v_mfma_f32_16x16x32_bf16 v[232:235], a[136:139], v[52:55], v[232:235]
  v_exp_f32_e64 v34, v34
  v_mfma_f32_16x16x32_bf16 v[236:239], a[140:143], v[52:55], v[236:239]
  ds_read_b64_tr_b16 a[182:183], v13 offset:20480
  v_mfma_f32_16x16x32_bf16 v[240:243], a[144:147], v[52:55], v[240:243]
  v_exp_f32_e64 v35, v35
  v_mfma_f32_16x16x32_bf16 v[244:247], a[148:151], v[52:55], v[244:247]
  ds_read_b64_tr_b16 a[184:185], v14 offset:16384
  v_cvt_pk_bf16_f32 v49, v34, v35
  v_mfma_f32_16x16x32_bf16 v[248:251], a[152:155], v[52:55], v[248:251]
  v_exp_f32_e64 v36, v36
  v_mfma_f32_16x16x32_bf16 v[252:255], a[156:159], v[52:55], v[252:255]
  ds_read_b64_tr_b16 a[186:187], v14 offset:20480
  buffer_load_dwordx4 v83, s[20:23], s63 offen offset:3072  lds
  v_mfma_f32_16x16x32_bf16 v[40:43], a[96:99], a[48:51], v[68:71]
  v_exp_f32_e64 v37, v37
  v_mfma_f32_16x16x32_bf16 v[40:43], a[100:103], a[52:55], v[40:43]
  ds_read_b64_tr_b16 a[188:189], v15 offset:16384
  v_cvt_pk_bf16_f32 v50, v36, v37
  v_mfma_f32_16x16x32_bf16 v[40:43], a[104:107], a[56:59], v[40:43]
  v_exp_f32_e64 v38, v38
  v_mfma_f32_16x16x32_bf16 v[40:43], a[108:111], a[60:63], v[40:43]
  ds_read_b64_tr_b16 a[190:191], v15 offset:20480
  v_mfma_f32_16x16x32_bf16 v[44:47], a[124:127], a[60:63], v[68:71]
  v_exp_f32_e64 v39, v39
  v_mfma_f32_16x16x32_bf16 v[44:47], a[120:123], a[56:59], v[44:47]
  v_cvt_pk_bf16_f32 v51, v38, v39
  v_mfma_f32_16x16x32_bf16 v[44:47], a[116:119], a[52:55], v[44:47]
  v_mov_b32 v90, v106
  v_mov_b32 v91, v107
  v_mfma_f32_16x16x32_bf16 v[44:47], a[112:115], a[48:51], v[44:47]
  s_waitcnt lgkmcnt(3)
  v_exp_f32 v40, v40
  v_mfma_f32_16x16x32_bf16 v[192:195], a[160:163], v[48:51], v[192:195]
  v_mov_b32 v106, 0
  v_mov_b32 v107, 0
  v_mfma_f32_16x16x32_bf16 v[196:199], a[164:167], v[48:51], v[196:199]
  v_exp_f32_e64 v41, v41
  v_mfma_f32_16x16x32_bf16 v[200:203], a[168:171], v[48:51], v[200:203]
  v_cvt_pk_bf16_f32 v52, v40, v41
  v_mfma_f32_16x16x32_bf16 v[204:207], a[172:175], v[48:51], v[204:207]
  v_exp_f32_e64 v42, v42
  v_mfma_f32_16x16x32_bf16 v[208:211], a[176:179], v[48:51], v[208:211]
  v_mfma_f32_16x16x32_bf16 v[212:215], a[180:183], v[48:51], v[212:215]
  s_waitcnt lgkmcnt(0)
  v_exp_f32 v43, v43
  v_mfma_f32_16x16x32_bf16 v[216:219], a[184:187], v[48:51], v[216:219]
  v_cvt_pk_bf16_f32 v53, v42, v43
  v_mfma_f32_16x16x32_bf16 v[220:223], a[188:191], v[48:51], v[220:223]
  s_waitcnt vmcnt(8)
  v_exp_f32 v44, v44
  v_mfma_f32_16x16x32_bf16 v[32:35], a[64:67], a[0:3], v[56:59]
  s_barrier
  v_mfma_f32_16x16x32_bf16 v[32:35], a[68:71], a[4:7], v[32:35]
  ds_read_b64_tr_b16 a[192:193], v124 offset:0
  v_exp_f32 v45, v45
  v_mfma_f32_16x16x32_bf16 v[32:35], a[72:75], a[8:11], v[32:35]
  s_xor_b32 s63, s53, 0
  ds_read_b64_tr_b16 a[194:195], v124 offset:4096
  v_cvt_pk_bf16_f32 v54, v44, v45
  v_cvt_pk_bf16_f32 v192, v192, v193
  v_cvt_pk_bf16_f32 v193, v194, v195
  v_mfma_f32_16x16x32_bf16 v[32:35], a[76:79], a[12:15], v[32:35]
  s_add_u32 m0, s41, 16384
  v_exp_f32 v46, v46
  v_mfma_f32_16x16x32_bf16 v[36:39], a[92:95], a[12:15], v[56:59]
  buffer_load_dwordx4 v80, s[20:23], s63 offen offset:0  lds
  v_cvt_pk_bf16_f32 v194, v196, v197
  v_cvt_pk_bf16_f32 v195, v198, v199
  v_cvt_pk_bf16_f32 v200, v200, v201
  v_mfma_f32_16x16x32_bf16 v[36:39], a[88:91], a[8:11], v[36:39]
  ds_read_b64_tr_b16 a[196:197], v125 offset:0
  v_exp_f32_e64 v47, v47
  v_mfma_f32_16x16x32_bf16 v[36:39], a[84:87], a[4:7], v[36:39]
  ds_write_b128 v101, v[192:195] offset:0
  v_cvt_pk_bf16_f32 v55, v46, v47
  v_cvt_pk_bf16_f32 v201, v202, v203
  v_mfma_f32_16x16x32_bf16 v[36:39], a[80:83], a[0:3], v[36:39]
  v_exp_f32_e64 v32, v32
  v_smfmac_f32_16x16x64_bf16 v[108:111], v[120:123], v[48:55], v78
  buffer_load_dwordx4 v81, s[20:23], s63 offen offset:1024  lds
  v_cvt_pk_bf16_f32 v202, v204, v205
  v_cvt_pk_bf16_f32 v203, v206, v207
  v_cvt_pk_bf16_f32 v208, v208, v209
  v_mfma_f32_16x16x32_bf16 v[224:227], a[160:163], v[52:55], v[224:227]
  ds_read_b64_tr_b16 a[198:199], v125 offset:4096
  v_exp_f32_e64 v33, v33
  v_mfma_f32_16x16x32_bf16 v[228:231], a[164:167], v[52:55], v[228:231]
  ds_write_b128 v101, v[200:203] offset:4096
  v_cvt_pk_bf16_f32 v48, v32, v33
  v_cvt_pk_bf16_f32 v209, v210, v211
  v_mfma_f32_16x16x32_bf16 v[232:235], a[168:171], v[52:55], v[232:235]
  v_exp_f32_e64 v34, v34
  v_mfma_f32_16x16x32_bf16 v[236:239], a[172:175], v[52:55], v[236:239]
  buffer_load_dwordx4 v82, s[20:23], s63 offen offset:2048  lds
  v_cvt_pk_bf16_f32 v210, v212, v213
  v_cvt_pk_bf16_f32 v211, v214, v215
  v_cvt_pk_bf16_f32 v216, v216, v217
  v_mfma_f32_16x16x32_bf16 v[240:243], a[176:179], v[52:55], v[240:243]
L_w5:
  s_cbranch_execz L_wdone
  ds_read_b64_tr_b16 a[200:201], v124 offset:8192
  v_exp_f32 v35, v35
  v_mfma_f32_16x16x32_bf16 v[244:247], a[180:183], v[52:55], v[244:247]
  ds_write_b128 v101, v[208:211] offset:8192
  v_cvt_pk_bf16_f32 v49, v34, v35
  v_cvt_pk_bf16_f32 v217, v218, v219
  v_mfma_f32_16x16x32_bf16 v[248:251], a[184:187], v[52:55], v[248:251]
  v_exp_f32_e64 v36, v36
  v_mfma_f32_16x16x32_bf16 v[252:255], a[188:191], v[52:55], v[252:255]
  buffer_load_dwordx4 v83, s[20:23], s63 offen offset:3072  lds
  v_cvt_pk_bf16_f32 v218, v220, v221
  v_cvt_pk_bf16_f32 v219, v222, v223
  v_add_f32_e64 v108, v108, v109
  v_mfma_f32_16x16x32_bf16 v[40:43], a[96:99], a[0:3], v[56:59]
  ds_read_b64_tr_b16 a[202:203], v124 offset:12288
  v_exp_f32_e64 v37, v37
  v_mfma_f32_16x16x32_bf16 v[40:43], a[100:103], a[4:7], v[40:43]
  s_xor_b32 s63, s53, 65536
  ds_write_b128 v101, v[216:219] offset:12288
  v_cvt_pk_bf16_f32 v50, v36, v37
  v_add_f32_e64 v109, v110, v111
  v_mfma_f32_16x16x32_bf16 v[40:43], a[104:107], a[8:11], v[40:43]
  s_add_u32 m0, s41, 114688
  v_exp_f32_e64 v38, v38
  v_mfma_f32_16x16x32_bf16 v[40:43], a[108:111], a[12:15], v[40:43]
  buffer_load_dwordx4 v80, s[20:23], s63 offen offset:0  lds
  v_cvt_pk_bf16_f32 v224, v224, v225
  v_cvt_pk_bf16_f32 v225, v226, v227
  v_cvt_pk_bf16_f32 v226, v228, v229
  v_mfma_f32_16x16x32_bf16 v[44:47], a[124:127], a[12:15], v[56:59]
  ds_read_b64_tr_b16 a[204:205], v125 offset:8192
  v_exp_f32_e64 v39, v39
  v_mfma_f32_16x16x32_bf16 v[44:47], a[120:123], a[8:11], v[44:47]
  ds_write_b64 v103, v[108:109]
  ds_read_b64_tr_b16 a[206:207], v125 offset:12288
  v_cvt_pk_bf16_f32 v51, v38, v39
  v_cvt_pk_bf16_f32 v227, v230, v231
  v_mfma_f32_16x16x32_bf16 v[44:47], a[116:119], a[4:7], v[44:47]
  ds_read_b64_tr_b16 a[208:209], v124 offset:16384
  v_cvt_pk_bf16_f32 v232, v232, v233
  v_cvt_pk_bf16_f32 v233, v234, v235
  v_cvt_pk_bf16_f32 v234, v236, v237
  v_mfma_f32_16x16x32_bf16 v[44:47], a[112:115], a[0:3], v[44:47]
  ds_read_b64_tr_b16 a[210:211], v124 offset:20480
  v_exp_f32_e64 v40, v40
  v_mfma_f32_16x16x32_bf16 v[128:131], a[128:131], v[48:51], v[128:131]
  buffer_load_dwordx4 v81, s[20:23], s63 offen offset:1024  lds
  v_cvt_pk_bf16_f32 v235, v238, v239
  v_cvt_pk_bf16_f32 v240, v240, v241
  v_cvt_pk_bf16_f32 v241, v242, v243
  v_mfma_f32_16x16x32_bf16 v[132:135], a[132:135], v[48:51], v[132:135]
  ds_read_b64_tr_b16 a[212:213], v125 offset:16384
  v_exp_f32_e64 v41, v41
  v_mfma_f32_16x16x32_bf16 v[136:139], a[136:139], v[48:51], v[136:139]
  ds_write_b128 v101, v[224:227] offset:1024
  v_cvt_pk_bf16_f32 v52, v40, v41
  v_cvt_pk_bf16_f32 v242, v244, v245
  v_mfma_f32_16x16x32_bf16 v[140:143], a[140:143], v[48:51], v[140:143]
  v_exp_f32_e64 v42, v42
  v_mfma_f32_16x16x32_bf16 v[144:147], a[144:147], v[48:51], v[144:147]
  buffer_load_dwordx4 v82, s[20:23], s63 offen offset:2048  lds
  v_cvt_pk_bf16_f32 v243, v246, v247
  v_cvt_pk_bf16_f32 v248, v248, v249
  v_cvt_pk_bf16_f32 v249, v250, v251
  v_mfma_f32_16x16x32_bf16 v[148:151], a[148:151], v[48:51], v[148:151]
  ds_read_b64_tr_b16 a[214:215], v125 offset:20480
  v_exp_f32_e64 v43, v43
  v_mfma_f32_16x16x32_bf16 v[152:155], a[152:155], v[48:51], v[152:155]
  ds_write_b128 v101, v[232:235] offset:5120
  v_cvt_pk_bf16_f32 v53, v42, v43
  v_cvt_pk_bf16_f32 v250, v252, v253
  v_mfma_f32_16x16x32_bf16 v[156:159], a[156:159], v[48:51], v[156:159]
  v_exp_f32_e64 v44, v44
  v_mfma_f32_16x16x32_bf16 v[32:35], a[64:67], a[16:19], v[60:63]
  buffer_load_dwordx4 v83, s[20:23], s63 offen offset:3072  lds
  ds_read_b64_tr_b16 a[216:217], v124 offset:24576
  v_cvt_pk_bf16_f32 v251, v254, v255
  v_mfma_f32_16x16x32_bf16 v[32:35], a[68:71], a[20:23], v[32:35]
  v_exp_f32_e64 v45, v45
  v_mfma_f32_16x16x32_bf16 v[32:35], a[72:75], a[24:27], v[32:35]
  s_xor_b32 s63, s53, 131072
  ds_write_b128 v101, v[240:243] offset:9216
  v_cvt_pk_bf16_f32 v54, v44, v45
  v_mfma_f32_16x16x32_bf16 v[32:35], a[76:79], a[28:31], v[32:35]
  s_add_u32 m0, s41, 32768
  v_exp_f32_e64 v46, v46
  v_mfma_f32_16x16x32_bf16 v[36:39], a[92:95], a[28:31], v[60:63]
  buffer_load_dwordx4 v80, s[20:23], s63 offen offset:0  lds
  ds_read_b64_tr_b16 a[218:219], v124 offset:28672
  ds_read_b64_tr_b16 a[220:221], v125 offset:24576
  ds_read_b64_tr_b16 a[222:223], v125 offset:28672
  v_mfma_f32_16x16x32_bf16 v[36:39], a[88:91], a[24:27], v[36:39]
  v_exp_f32_e64 v47, v47
  v_mfma_f32_16x16x32_bf16 v[36:39], a[84:87], a[20:23], v[36:39]
  ds_write_b128 v101, v[248:251] offset:13312
  v_cvt_pk_bf16_f32 v55, v46, v47
  v_mfma_f32_16x16x32_bf16 v[36:39], a[80:83], a[16:19], v[36:39]
  v_exp_f32_e64 v32, v32
  v_smfmac_f32_16x16x64_bf16 v[104:107], v[120:123], v[48:55], v78
  buffer_load_dwordx4 v81, s[20:23], s63 offen offset:1024  lds
  v_mfma_f32_16x16x32_bf16 v[128:131], a[160:163], v[52:55], v[128:131]
  s_waitcnt lgkmcnt(0)
  v_exp_f32 v33, v33
  v_mfma_f32_16x16x32_bf16 v[132:135], a[164:167], v[52:55], v[132:135]
  s_barrier
  ds_read_b128 a[32:35], v100 offset:0
  v_cvt_pk_bf16_f32 v48, v32, v33
  v_mfma_f32_16x16x32_bf16 v[136:139], a[168:171], v[52:55], v[136:139]
  v_exp_f32 v34, v34
  v_mfma_f32_16x16x32_bf16 v[140:143], a[172:175], v[52:55], v[140:143]
  ds_read_b128 a[36:39], v100 offset:4096
  ds_read_b128 a[40:43], v100 offset:8192
  ds_read_b128 a[44:47], v100 offset:12288
  v_mfma_f32_16x16x32_bf16 v[144:147], a[176:179], v[52:55], v[144:147]
  v_exp_f32_e64 v35, v35
  v_mfma_f32_16x16x32_bf16 v[148:151], a[180:183], v[52:55], v[148:151]
  ds_read_b64 v[112:113], v102
  buffer_load_dwordx4 v82, s[20:23], s63 offen offset:2048  lds
  v_cvt_pk_bf16_f32 v49, v34, v35
  v_mfma_f32_16x16x32_bf16 v[152:155], a[184:187], v[52:55], v[152:155]
  v_exp_f32_e64 v36, v36
  v_mfma_f32_16x16x32_bf16 v[156:159], a[188:191], v[52:55], v[156:159]
  s_waitcnt lgkmcnt(4)
  ds_read_b128 a[48:51], v100 offset:1024
  buffer_load_dwordx4 v83, s[20:23], s63 offen offset:3072  lds
  v_mfma_f32_16x16x32_bf16 v[128:131], v[86:89], a[32:35], v[128:131]
  v_exp_f32 v37, v37
  v_mfma_f32_16x16x32_bf16 v[132:135], v[84:87], a[32:35], v[132:135]
  s_waitcnt lgkmcnt(4)
  s_xor_b32 s63, s53, 196608
  ds_read_b128 a[52:55], v100 offset:5120
  v_cvt_pk_bf16_f32 v50, v36, v37
  v_add_f32 v104, v104, v105
  v_mfma_f32_16x16x32_bf16 v[136:139], v[86:89], a[36:39], v[136:139]
  s_add_u32 m0, s41, 131072
  v_exp_f32_e64 v38, v38
  v_mfma_f32_16x16x32_bf16 v[140:143], v[84:87], a[36:39], v[140:143]
  ds_read_b128 a[56:59], v100 offset:9216
  buffer_load_dwordx4 v80, s[20:23], s63 offen offset:0  lds
  v_add_f32 v106, v106, v107
  s_waitcnt lgkmcnt(3)
  v_add_f32_e64 v104, v104, v112
  v_mfma_f32_16x16x32_bf16 v[144:147], v[86:89], a[40:43], v[144:147]
  v_exp_f32_e64 v39, v39
  v_mfma_f32_16x16x32_bf16 v[148:151], v[84:87], a[40:43], v[148:151]
  ds_read_b128 a[60:63], v100 offset:13312
  v_cvt_pk_bf16_f32 v51, v38, v39
  v_add_f32_e64 v1, v104, v106
  v_mfma_f32_16x16x32_bf16 v[152:155], v[86:89], a[44:47], v[152:155]
  buffer_load_dwordx4 v81, s[20:23], s63 offen offset:1024  lds
  v_rcp_f32_e64 v26, v1
  v_mfma_f32_16x16x32_bf16 v[156:159], v[84:87], a[44:47], v[156:159]
  v_mul_f32 v128, v26, v128
  v_mul_f32 v129, v26, v129
  v_mul_f32_e64 v130, v26, v130
  v_mfma_f32_16x16x32_bf16 v[40:43], a[96:99], a[16:19], v[60:63]
  v_mul_f32 v131, v26, v131
  v_mul_f32 v132, v26, v132
  v_mul_f32_e64 v133, v26, v133
  v_mfma_f32_16x16x32_bf16 v[40:43], a[100:103], a[20:23], v[40:43]
  v_mul_f32 v134, v26, v134
  v_mul_f32 v135, v26, v135
  v_cvt_pk_bf16_f32 v128, v128, v129
  v_mfma_f32_16x16x32_bf16 v[40:43], a[104:107], a[24:27], v[40:43]
  v_cvt_pk_bf16_f32 v129, v130, v131
  v_cvt_pk_bf16_f32 v130, v132, v133
  v_cvt_pk_bf16_f32 v131, v134, v135
  v_mfma_f32_16x16x32_bf16 v[40:43], a[108:111], a[28:31], v[40:43]
  s_waitcnt vmcnt(14)
  ds_write_b128 v100, v[128:131] offset:0
  v_mul_f32 v136, v26, v136
  v_mul_f32_e64 v137, v26, v137
  v_mfma_f32_16x16x32_bf16 v[44:47], a[124:127], a[28:31], v[60:63]
  s_barrier
  v_mul_f32 v138, v26, v138
  v_mul_f32 v139, v26, v139
  v_mul_f32 v140, v26, v140
  v_mfma_f32_16x16x32_bf16 v[44:47], a[120:123], a[24:27], v[44:47]
  buffer_load_dwordx4 v82, s[20:23], s63 offen offset:2048  lds
  v_mul_f32 v141, v26, v141
  v_mul_f32 v142, v26, v142
  v_mul_f32_e64 v143, v26, v143
  v_mfma_f32_16x16x32_bf16 v[44:47], a[116:119], a[20:23], v[44:47]
  ds_read_b64_tr_b16 a[224:225], v116 offset:0
  v_cvt_pk_bf16_f32 v136, v136, v137
  v_cvt_pk_bf16_f32 v137, v138, v139
  v_cvt_pk_bf16_f32 v138, v140, v141
  v_mfma_f32_16x16x32_bf16 v[44:47], a[112:115], a[16:19], v[44:47]
  ds_read_b64_tr_b16 a[226:227], v116 offset:4096
  v_exp_f32_e64 v40, v40
  v_mfma_f32_16x16x32_bf16 v[160:163], a[128:131], v[48:51], v[160:163]
  buffer_load_dwordx4 v83, s[20:23], s63 offen offset:3072  lds
  v_cvt_pk_bf16_f32 v139, v142, v143
  v_mul_f32 v144, v26, v144
  v_mul_f32 v145, v26, v145
  v_mfma_f32_16x16x32_bf16 v[164:167], a[132:135], v[48:51], v[164:167]
  ds_read_b64_tr_b16 a[228:229], v117 offset:0
  v_exp_f32_e64 v41, v41
  v_mfma_f32_16x16x32_bf16 v[168:171], a[136:139], v[48:51], v[168:171]
  ds_write_b128 v100, v[136:139] offset:4096
  v_cvt_pk_bf16_f32 v52, v40, v41
  v_mul_f32_e64 v146, v26, v146
  v_mfma_f32_16x16x32_bf16 v[172:175], a[140:143], v[48:51], v[172:175]
  s_xor_b32 s63, s54, 0
  v_exp_f32 v42, v42
  v_mfma_f32_16x16x32_bf16 v[176:179], a[144:147], v[48:51], v[176:179]
  ds_read_b64_tr_b16 a[230:231], v117 offset:4096
  v_mul_f32 v147, v26, v147
  v_mul_f32 v148, v26, v148
  v_mul_f32_e64 v149, v26, v149
  v_mfma_f32_16x16x32_bf16 v[180:183], a[148:151], v[48:51], v[180:183]
  s_add_u32 m0, s41, 147456
  ds_read_b64_tr_b16 a[232:233], v116 offset:8192
  v_exp_f32_e64 v43, v43
  v_mfma_f32_16x16x32_bf16 v[184:187], a[152:155], v[48:51], v[184:187]
  buffer_load_dwordx4 v80, s[20:23], s63 offen offset:0  lds
  v_cvt_pk_bf16_f32 v53, v42, v43
  v_mul_f32 v150, v26, v150
  v_mul_f32 v151, v26, v151
  v_mfma_f32_16x16x32_bf16 v[188:191], a[156:159], v[48:51], v[188:191]
  s_waitcnt lgkmcnt(5)
  ds_read_b64_tr_b16 a[234:235], v116 offset:12288
  v_exp_f32 v44, v44
  v_mfma_f32_16x16x32_bf16 v[160:163], v[86:89], a[48:51], v[160:163]
  ds_read_b64_tr_b16 a[236:237], v117 offset:8192
  v_cvt_pk_bf16_f32 v144, v144, v145
  v_cvt_pk_bf16_f32 v145, v146, v147
  v_cvt_pk_bf16_f32 v146, v148, v149
  v_mfma_f32_16x16x32_bf16 v[164:167], v[84:87], a[48:51], v[164:167]
  ds_read_b64_tr_b16 a[238:239], v117 offset:12288
  v_exp_f32_e64 v45, v45
  v_mfma_f32_16x16x32_bf16 v[168:171], v[86:89], a[52:55], v[168:171]
  buffer_load_dwordx4 v81, s[20:23], s63 offen offset:1024  lds
  v_cvt_pk_bf16_f32 v54, v44, v45
  v_cvt_pk_bf16_f32 v147, v150, v151
  v_mul_f32_e64 v152, v26, v152
  v_mfma_f32_16x16x32_bf16 v[172:175], v[84:87], a[52:55], v[172:175]
  ds_read_b64_tr_b16 a[240:241], v118 offset:32768
  v_exp_f32_e64 v46, v46
  v_mfma_f32_16x16x32_bf16 v[176:179], v[86:89], a[56:59], v[176:179]
  ds_write_b128 v100, v[144:147] offset:8192
  v_mul_f32 v153, v26, v153
  v_mul_f32 v154, v26, v154
  v_mfma_f32_16x16x32_bf16 v[180:183], v[84:87], a[56:59], v[180:183]
  v_exp_f32_e64 v47, v47
  v_mfma_f32_16x16x32_bf16 v[184:187], v[86:89], a[60:63], v[184:187]
  ds_read_b64_tr_b16 a[242:243], v118 offset:36864
  v_cvt_pk_bf16_f32 v55, v46, v47
  v_mul_f32 v155, v26, v155
  v_mul_f32 v156, v26, v156
  v_mfma_f32_16x16x32_bf16 v[188:191], v[84:87], a[60:63], v[188:191]
  v_mul_f32 v157, v26, v157
  v_mul_f32 v158, v26, v158
  v_mul_f32_e64 v159, v26, v159
  v_smfmac_f32_16x16x64_bf16 v[90:93], v[120:123], v[48:55], v78
  v_cvt_pk_bf16_f32 v152, v152, v153
  v_cvt_pk_bf16_f32 v153, v154, v155
  v_cvt_pk_bf16_f32 v154, v156, v157
  v_mfma_f32_16x16x32_bf16 v[160:163], a[160:163], v[52:55], v[160:163]
  buffer_load_dwordx4 v82, s[20:23], s63 offen offset:2048  lds
  ds_read_b64_tr_b16 a[244:245], v119 offset:32768
  v_cvt_pk_bf16_f32 v155, v158, v159
  v_mfma_f32_16x16x32_bf16 v[164:167], a[164:167], v[52:55], v[164:167]
  ds_write_b128 v100, v[152:155] offset:12288
  v_mfma_f32_16x16x32_bf16 v[168:171], a[168:171], v[52:55], v[168:171]
  v_mfma_f32_16x16x32_bf16 v[172:175], a[172:175], v[52:55], v[172:175]
  buffer_load_dwordx4 v83, s[20:23], s63 offen offset:3072  lds
  ds_read_b64_tr_b16 a[246:247], v119 offset:36864
  v_mfma_f32_16x16x32_bf16 v[176:179], a[176:179], v[52:55], v[176:179]
  ds_read_b64_tr_b16 a[248:249], v118 offset:40960
  ds_read_b64_tr_b16 a[250:251], v118 offset:45056
  ds_read_b64_tr_b16 a[252:253], v119 offset:40960
  ds_read_b64_tr_b16 a[254:255], v119 offset:45056
  v_mfma_f32_16x16x32_bf16 v[180:183], a[180:183], v[52:55], v[180:183]
  v_mfma_f32_16x16x32_bf16 v[184:187], a[184:187], v[52:55], v[184:187]
  v_mfma_f32_16x16x32_bf16 v[188:191], a[188:191], v[52:55], v[188:191]
L_norm:
  v_add_f32 v90, v90, v91
  v_add_f32 v92, v92, v93
  v_add_f32 v90, v90, v113
  v_add_f32 v2, v90, v92
  v_rcp_f32_e64 v27, v2
  s_waitcnt vmcnt(12) lgkmcnt(0)
  s_barrier
  ds_read_b128 a[0:3], v94 offset:0
  ds_read_b128 a[16:19], v94 offset:4096
  ds_read_b128 a[32:35], v94 offset:8192
  ds_read_b128 a[48:51], v94 offset:12288
  ds_read_b128 a[64:67], v95 offset:0
  ds_read_b128 a[80:83], v95 offset:4096
  ds_read_b128 a[96:99], v95 offset:8192
  ds_read_b128 a[112:115], v95 offset:12288
  v_add_f32_e64 v25, v1, v2
  v_pk_mul_f32 v[160:161], v[160:161], v[26:27] op_sel:[0,1] op_sel_hi:[1,1]
  v_pk_mul_f32 v[162:163], v[162:163], v[26:27] op_sel:[0,1] op_sel_hi:[1,1]
  v_pk_mul_f32 v[164:165], v[164:165], v[26:27] op_sel:[0,1] op_sel_hi:[1,1]
  v_pk_mul_f32 v[166:167], v[166:167], v[26:27] op_sel:[0,1] op_sel_hi:[1,1]
  v_cvt_pk_bf16_f32 v160, v160, v161
  v_cvt_pk_bf16_f32 v161, v162, v163
  v_cvt_pk_bf16_f32 v162, v164, v165
  v_cvt_pk_bf16_f32 v163, v166, v167
  ds_write_b128 v100, v[160:163] offset:1024
  v_pk_mul_f32 v[168:169], v[168:169], v[26:27] op_sel:[0,1] op_sel_hi:[1,1]
  v_pk_mul_f32 v[170:171], v[170:171], v[26:27] op_sel:[0,1] op_sel_hi:[1,1]
  v_pk_mul_f32 v[172:173], v[172:173], v[26:27] op_sel:[0,1] op_sel_hi:[1,1]
  v_pk_mul_f32 v[174:175], v[174:175], v[26:27] op_sel:[0,1] op_sel_hi:[1,1]
  v_cvt_pk_bf16_f32 v168, v168, v169
  v_cvt_pk_bf16_f32 v169, v170, v171
  v_cvt_pk_bf16_f32 v170, v172, v173
  v_cvt_pk_bf16_f32 v171, v174, v175
  ds_write_b128 v100, v[168:171] offset:5120
  v_pk_mul_f32 v[176:177], v[176:177], v[26:27] op_sel:[0,1] op_sel_hi:[1,1]
  v_pk_mul_f32 v[178:179], v[178:179], v[26:27] op_sel:[0,1] op_sel_hi:[1,1]
  v_pk_mul_f32 v[180:181], v[180:181], v[26:27] op_sel:[0,1] op_sel_hi:[1,1]
  v_pk_mul_f32 v[182:183], v[182:183], v[26:27] op_sel:[0,1] op_sel_hi:[1,1]
  v_cvt_pk_bf16_f32 v176, v176, v177
  v_cvt_pk_bf16_f32 v177, v178, v179
  v_cvt_pk_bf16_f32 v178, v180, v181
  v_cvt_pk_bf16_f32 v179, v182, v183
  ds_write_b128 v100, v[176:179] offset:9216
  v_pk_mul_f32 v[184:185], v[184:185], v[26:27] op_sel:[0,1] op_sel_hi:[1,1]
  v_pk_mul_f32 v[186:187], v[186:187], v[26:27] op_sel:[0,1] op_sel_hi:[1,1]
  v_pk_mul_f32 v[188:189], v[188:189], v[26:27] op_sel:[0,1] op_sel_hi:[1,1]
  v_pk_mul_f32 v[190:191], v[190:191], v[26:27] op_sel:[0,1] op_sel_hi:[1,1]
  v_cvt_pk_bf16_f32 v184, v184, v185
  v_cvt_pk_bf16_f32 v185, v186, v187
  v_cvt_pk_bf16_f32 v186, v188, v189
  v_cvt_pk_bf16_f32 v187, v190, v191
  s_waitcnt lgkmcnt(10)
  v_mfma_f32_16x16x32_bf16 v[128:131], a[192:195], a[0:3], 0
  s_waitcnt lgkmcnt(9)
  s_xor_b32 s63, s54, 65536
  ds_read_b128 a[8:11], v94 offset:2048
  v_mfma_f32_16x16x32_bf16 v[128:131], a[200:203], a[16:19], v[128:131]
  s_waitcnt lgkmcnt(9)
  s_add_u32 m0, s41, 0
  ds_read_b128 a[24:27], v94 offset:6144
  ds_write_b32 v72, v25 offset:4096
  v_mfma_f32_16x16x32_bf16 v[128:131], a[208:211], a[32:35], v[128:131]
  s_waitcnt lgkmcnt(10)
  ds_read_b128 a[40:43], v94 offset:10240
  buffer_load_dwordx4 v80, s[20:23], s63 offen offset:0  lds
  v_mfma_f32_16x16x32_bf16 v[128:131], a[216:219], a[48:51], v[128:131]
  s_waitcnt lgkmcnt(10)
  ds_read_b128 a[56:59], v94 offset:14336
  ds_write_b128 v100, v[184:187] offset:13312
  v_mfma_f32_16x16x32_bf16 v[128:131], a[224:227], a[64:67], v[128:131]
  s_waitcnt lgkmcnt(11)
  ds_read_b128 a[72:75], v95 offset:2048
  v_mfma_f32_16x16x32_bf16 v[128:131], a[232:235], a[80:83], v[128:131]
  s_waitcnt lgkmcnt(11)
  ds_read_b128 a[88:91], v95 offset:6144
  buffer_load_dwordx4 v81, s[20:23], s63 offen offset:1024  lds
  v_mfma_f32_16x16x32_bf16 v[128:131], a[240:243], a[96:99], v[128:131]
  s_waitcnt lgkmcnt(11)
  ds_read_b128 a[104:107], v95 offset:10240
  ds_read_b64_tr_b16 a[128:129], v116 offset:16384
  v_mfma_f32_16x16x32_bf16 v[128:131], a[248:251], a[112:115], v[128:131]
  ds_read_b128 a[120:123], v95 offset:14336
  ds_read_b64_tr_b16 a[130:131], v116 offset:20480
  v_mfma_f32_16x16x32_bf16 v[132:135], a[252:255], a[112:115], 0
  buffer_load_dwordx4 v82, s[20:23], s63 offen offset:2048  lds
  ds_read_b64_tr_b16 a[132:133], v117 offset:16384
  v_mfma_f32_16x16x32_bf16 v[132:135], a[244:247], a[96:99], v[132:135]
  buffer_load_dwordx4 v83, s[20:23], s63 offen offset:3072  lds
  ds_read_b64_tr_b16 a[134:135], v117 offset:20480
  v_mfma_f32_16x16x32_bf16 v[132:135], a[236:239], a[80:83], v[132:135]
  s_xor_b32 s63, s54, 131072
  s_add_u32 m0, s41, 98304
  ds_read_b64_tr_b16 a[136:137], v116 offset:24576
  ds_read_b64_tr_b16 a[138:139], v116 offset:28672
  v_mfma_f32_16x16x32_bf16 v[132:135], a[228:231], a[64:67], v[132:135]
  buffer_load_dwordx4 v80, s[20:23], s63 offen offset:0  lds
  ds_read_b64_tr_b16 a[140:141], v117 offset:24576
  v_mfma_f32_16x16x32_bf16 v[132:135], a[220:223], a[48:51], v[132:135]
  ds_read_b64_tr_b16 a[142:143], v117 offset:28672
  ds_read_b64_tr_b16 a[144:145], v118 offset:49152
  v_mfma_f32_16x16x32_bf16 v[132:135], a[212:215], a[32:35], v[132:135]
  buffer_load_dwordx4 v81, s[20:23], s63 offen offset:1024  lds
  ds_read_b64_tr_b16 a[146:147], v118 offset:53248
  v_mfma_f32_16x16x32_bf16 v[132:135], a[204:207], a[16:19], v[132:135]
  ds_read_b64_tr_b16 a[148:149], v119 offset:49152
  ds_read_b64_tr_b16 a[150:151], v119 offset:53248
  ds_read_b64_tr_b16 a[152:153], v118 offset:57344
  v_mfma_f32_16x16x32_bf16 v[132:135], a[196:199], a[0:3], v[132:135]
  s_waitcnt lgkmcnt(13)
  ds_read_b64_tr_b16 a[154:155], v118 offset:61440
  ds_read_b64_tr_b16 a[156:157], v119 offset:57344
  v_mfma_f32_16x16x32_bf16 v[148:151], a[196:199], a[8:11], 0
  buffer_load_dwordx4 v82, s[20:23], s63 offen offset:2048  lds
  ds_read_b64_tr_b16 a[158:159], v119 offset:61440
  v_mfma_f32_16x16x32_bf16 v[148:151], a[204:207], a[24:27], v[148:151]
  v_mfma_f32_16x16x32_bf16 v[148:151], a[212:215], a[40:43], v[148:151]
  buffer_load_dwordx4 v83, s[20:23], s63 offen offset:3072  lds
  v_mfma_f32_16x16x32_bf16 v[148:151], a[220:223], a[56:59], v[148:151]
  v_mfma_f32_16x16x32_bf16 v[148:151], a[228:231], a[72:75], v[148:151]
  s_xor_b32 s62, s51, 0
  v_cvt_pk_bf16_f32 v128, v128, v129
  v_cvt_pk_bf16_f32 v129, v130, v131
  v_mfma_f32_16x16x32_bf16 v[148:151], a[236:239], a[88:91], v[148:151]
  s_waitcnt vmcnt(8) lgkmcnt(0)
  v_cvt_pk_bf16_f32 v130, v132, v133
  v_cvt_pk_bf16_f32 v131, v134, v135
  v_mfma_f32_16x16x32_bf16 v[148:151], a[244:247], a[104:107], v[148:151]
  s_barrier
  ds_read_b128 a[4:7], v94 offset:1024
  ds_read_b128 a[20:23], v94 offset:5120
  v_mfma_f32_16x16x32_bf16 v[148:151], a[252:255], a[120:123], v[148:151]
  ds_read_b128 a[36:39], v94 offset:9216
  ds_read_b128 a[52:55], v94 offset:13312
  v_mfma_f32_16x16x32_bf16 v[144:147], a[248:251], a[120:123], 0
  ds_read_b128 v[32:35], v73 offset:4096
  ds_read_b128 a[68:71], v95 offset:1024
  v_mfma_f32_16x16x32_bf16 v[144:147], a[240:243], a[104:107], v[144:147]
  s_xor_b32 s63, s54, 196608
  ds_read_b128 a[84:87], v95 offset:5120
  ds_read_b128 a[100:103], v95 offset:9216
  v_mfma_f32_16x16x32_bf16 v[144:147], a[232:235], a[88:91], v[144:147]
  s_add_u32 m0, s41, 16384
  ds_read_b128 a[116:119], v95 offset:13312
  v_mfma_f32_16x16x32_bf16 v[144:147], a[224:227], a[72:75], v[144:147]
  buffer_load_dwordx4 v80, s[20:23], s63 offen offset:0  lds
  ds_read_b128 a[12:15], v94 offset:3072
  v_mfma_f32_16x16x32_bf16 v[144:147], a[216:219], a[56:59], v[144:147]
  ds_read_b128 a[28:31], v94 offset:7168
  v_mfma_f32_16x16x32_bf16 v[144:147], a[208:211], a[40:43], v[144:147]
  ds_read_b128 a[44:47], v94 offset:11264
  v_mfma_f32_16x16x32_bf16 v[144:147], a[200:203], a[24:27], v[144:147]
  buffer_load_dwordx4 v81, s[20:23], s63 offen offset:1024  lds
  v_mfma_f32_16x16x32_bf16 v[144:147], a[192:195], a[8:11], v[144:147]
  s_waitcnt lgkmcnt(10)
  ds_read_b128 a[60:63], v94 offset:15360
  v_mfma_f32_16x16x32_bf16 v[136:139], a[192:195], a[4:7], 0
  ds_read_b128 a[76:79], v95 offset:3072
  s_waitcnt lgkmcnt(9)
  v_add_f32 v32, v32, v33
  v_mfma_f32_16x16x32_bf16 v[136:139], a[200:203], a[20:23], v[136:139]
  ds_read_b128 a[92:95], v95 offset:7168
  v_add_f32_e64 v34, v34, v35
  v_mfma_f32_16x16x32_bf16 v[136:139], a[208:211], a[36:39], v[136:139]
  ds_read_b128 a[108:111], v95 offset:11264
  v_add_f32_e64 v32, v32, v34
  v_mfma_f32_16x16x32_bf16 v[136:139], a[216:219], a[52:55], v[136:139]
  s_waitcnt lgkmcnt(7)
  ds_read_b128 a[124:127], v95 offset:15360
  v_cmp_nge_f32 vcc, 0x4c000000, v32
  v_mfma_f32_16x16x32_bf16 v[136:139], a[224:227], a[68:71], v[136:139]
  s_cbranch_vccnz L_fail
L_fail_b:
  buffer_load_dwordx4 v82, s[20:23], s63 offen offset:2048  lds
  v_mfma_f32_16x16x32_bf16 v[136:139], a[232:235], a[84:87], v[136:139]
  buffer_store_dwordx4 v[128:131], v22, s[24:27], s62 offen sc1
  v_mfma_f32_16x16x32_bf16 v[136:139], a[240:243], a[100:103], v[136:139]
  s_xor_b32 s62, s51, 278528
  v_cvt_pk_bf16_f32 v144, v144, v145
  v_cvt_pk_bf16_f32 v145, v146, v147
  v_mfma_f32_16x16x32_bf16 v[136:139], a[248:251], a[116:119], v[136:139]
  v_cvt_pk_bf16_f32 v146, v148, v149
  v_cvt_pk_bf16_f32 v147, v150, v151
  v_mfma_f32_16x16x32_bf16 v[140:143], a[252:255], a[116:119], 0
  buffer_load_dwordx4 v83, s[20:23], s63 offen offset:3072  lds
  v_mfma_f32_16x16x32_bf16 v[140:143], a[244:247], a[100:103], v[140:143]
  buffer_store_dwordx4 v[144:147], v22, s[24:27], s62 offen sc1
  v_mfma_f32_16x16x32_bf16 v[140:143], a[236:239], a[84:87], v[140:143]
  v_mfma_f32_16x16x32_bf16 v[140:143], a[228:231], a[68:71], v[140:143]
  v_mfma_f32_16x16x32_bf16 v[140:143], a[220:223], a[52:55], v[140:143]
  s_xor_b32 s63, s55, 0
  v_mfma_f32_16x16x32_bf16 v[140:143], a[212:215], a[36:39], v[140:143]
  s_add_u32 m0, s41, 114688
  v_mfma_f32_16x16x32_bf16 v[140:143], a[204:207], a[20:23], v[140:143]
  buffer_load_dwordx4 v80, s[20:23], s63 offen offset:0  lds
  v_mfma_f32_16x16x32_bf16 v[140:143], a[196:199], a[4:7], v[140:143]
  s_waitcnt lgkmcnt(0)
  v_mfma_f32_16x16x32_bf16 v[156:159], a[196:199], a[12:15], 0
  v_mfma_f32_16x16x32_bf16 v[156:159], a[204:207], a[28:31], v[156:159]
  v_mfma_f32_16x16x32_bf16 v[156:159], a[212:215], a[44:47], v[156:159]
  v_mfma_f32_16x16x32_bf16 v[156:159], a[220:223], a[60:63], v[156:159]
  buffer_load_dwordx4 v81, s[20:23], s63 offen offset:1024  lds
  v_mfma_f32_16x16x32_bf16 v[156:159], a[228:231], a[76:79], v[156:159]
  s_barrier
  v_cvt_pk_bf16_f32 v136, v136, v137
  v_cvt_pk_bf16_f32 v137, v138, v139
  v_mfma_f32_16x16x32_bf16 v[156:159], a[236:239], a[92:95], v[156:159]
  s_xor_b32 s62, s51, 135168
  v_cvt_pk_bf16_f32 v138, v140, v141
  v_cvt_pk_bf16_f32 v139, v142, v143
  v_mfma_f32_16x16x32_bf16 v[156:159], a[244:247], a[108:111], v[156:159]
  v_mfma_f32_16x16x32_bf16 v[156:159], a[252:255], a[124:127], v[156:159]
  buffer_store_dwordx4 v[136:139], v22, s[24:27], s62 offen sc1
  v_mfma_f32_16x16x32_bf16 v[152:155], a[248:251], a[124:127], 0
  buffer_load_dwordx4 v82, s[20:23], s63 offen offset:2048  lds
  v_mfma_f32_16x16x32_bf16 v[152:155], a[240:243], a[108:111], v[152:155]
  v_mfma_f32_16x16x32_bf16 v[152:155], a[232:235], a[92:95], v[152:155]
  v_mfma_f32_16x16x32_bf16 v[152:155], a[224:227], a[76:79], v[152:155]
  v_mfma_f32_16x16x32_bf16 v[152:155], a[216:219], a[60:63], v[152:155]
  v_mfma_f32_16x16x32_bf16 v[152:155], a[208:211], a[44:47], v[152:155]
  buffer_load_dwordx4 v83, s[20:23], s63 offen offset:3072  lds
  v_mfma_f32_16x16x32_bf16 v[152:155], a[200:203], a[28:31], v[152:155]
  s_xor_b32 s63, s55, 65536
  v_mfma_f32_16x16x32_bf16 v[152:155], a[192:195], a[12:15], v[152:155]
  s_add_u32 m0, s41, 65536
  v_mfma_f32_16x16x32_bf16 v[160:163], a[128:131], a[0:3], 0
  buffer_load_dwordx4 v80, s[20:23], s63 offen offset:0  lds
  v_mfma_f32_16x16x32_bf16 v[160:163], a[136:139], a[16:19], v[160:163]
  v_mfma_f32_16x16x32_bf16 v[160:163], a[144:147], a[32:35], v[160:163]
  v_mfma_f32_16x16x32_bf16 v[160:163], a[152:155], a[48:51], v[160:163]
  v_mfma_f32_16x16x32_bf16 v[164:167], a[156:159], a[48:51], 0
  s_xor_b32 s62, s51, 413696
  v_cvt_pk_bf16_f32 v152, v152, v153
  v_cvt_pk_bf16_f32 v153, v154, v155
  v_mfma_f32_16x16x32_bf16 v[164:167], a[148:151], a[32:35], v[164:167]
  buffer_load_dwordx4 v81, s[20:23], s63 offen offset:1024  lds
  v_cvt_pk_bf16_f32 v154, v156, v157
  v_mfma_f32_16x16x32_bf16 v[164:167], a[140:143], a[16:19], v[164:167]
  v_cvt_pk_bf16_f32 v155, v158, v159
  v_mfma_f32_16x16x32_bf16 v[164:167], a[132:135], a[0:3], v[164:167]
  v_mfma_f32_16x16x32_bf16 v[172:175], a[132:135], a[4:7], 0
  ds_read_b64_tr_b16 a[160:161], v116 offset:32768
  ds_read_b64_tr_b16 a[162:163], v116 offset:36864
  v_mfma_f32_16x16x32_bf16 v[172:175], a[140:143], a[20:23], v[172:175]
  ds_read_b64_tr_b16 a[164:165], v117 offset:32768
  v_mfma_f32_16x16x32_bf16 v[172:175], a[148:151], a[36:39], v[172:175]
  buffer_load_dwordx4 v82, s[20:23], s63 offen offset:2048  lds
  v_mfma_f32_16x16x32_bf16 v[172:175], a[156:159], a[52:55], v[172:175]
  ds_read_b64_tr_b16 a[166:167], v117 offset:36864
  v_mfma_f32_16x16x32_bf16 v[168:171], a[152:155], a[52:55], 0
  ds_read_b64_tr_b16 a[168:169], v116 offset:40960
  v_mfma_f32_16x16x32_bf16 v[168:171], a[144:147], a[36:39], v[168:171]
  ds_read_b64_tr_b16 a[170:171], v116 offset:45056
  v_mfma_f32_16x16x32_bf16 v[168:171], a[136:139], a[20:23], v[168:171]
  ds_read_b64_tr_b16 a[172:173], v117 offset:40960
  v_mfma_f32_16x16x32_bf16 v[168:171], a[128:131], a[4:7], v[168:171]
  buffer_load_dwordx4 v83, s[20:23], s63 offen offset:3072  lds
  v_mfma_f32_16x16x32_bf16 v[176:179], a[128:131], a[8:11], 0
  ds_read_b64_tr_b16 a[174:175], v117 offset:45056
  v_mfma_f32_16x16x32_bf16 v[176:179], a[136:139], a[24:27], v[176:179]
  ds_read_b64_tr_b16 a[176:177], v124 offset:0
  ds_read_b64_tr_b16 a[178:179], v124 offset:4096
  v_mfma_f32_16x16x32_bf16 v[176:179], a[144:147], a[40:43], v[176:179]
  s_xor_b32 s63, s55, 131072
  ds_read_b64_tr_b16 a[180:181], v125 offset:0
  v_mfma_f32_16x16x32_bf16 v[176:179], a[152:155], a[56:59], v[176:179]
  s_add_u32 m0, s41, 49152
  ds_read_b64_tr_b16 a[182:183], v125 offset:4096
  v_mfma_f32_16x16x32_bf16 v[180:183], a[156:159], a[56:59], 0
L_w6:
  s_cbranch_execz L_wdone
  buffer_load_dwordx4 v80, s[20:23], s63 offen offset:0  lds
  v_mfma_f32_16x16x32_bf16 v[180:183], a[148:151], a[40:43], v[180:183]
  ds_read_b64_tr_b16 a[184:185], v124 offset:8192
  v_mfma_f32_16x16x32_bf16 v[180:183], a[140:143], a[24:27], v[180:183]
  ds_read_b64_tr_b16 a[186:187], v124 offset:12288
  v_mfma_f32_16x16x32_bf16 v[180:183], a[132:135], a[8:11], v[180:183]
  ds_read_b64_tr_b16 a[188:189], v125 offset:8192
  v_mfma_f32_16x16x32_bf16 v[188:191], a[132:135], a[12:15], 0
  ds_read_b64_tr_b16 a[190:191], v125 offset:12288
  v_mfma_f32_16x16x32_bf16 v[188:191], a[140:143], a[28:31], v[188:191]
  buffer_load_dwordx4 v81, s[20:23], s63 offen offset:1024  lds
  v_mfma_f32_16x16x32_bf16 v[188:191], a[148:151], a[44:47], v[188:191]
  buffer_store_dwordx4 v[152:155], v22, s[24:27], s62 offen sc1
  v_mfma_f32_16x16x32_bf16 v[188:191], a[156:159], a[60:63], v[188:191]
  v_mfma_f32_16x16x32_bf16 v[184:187], a[152:155], a[60:63], 0
  v_mfma_f32_16x16x32_bf16 v[184:187], a[144:147], a[44:47], v[184:187]
  v_mfma_f32_16x16x32_bf16 v[184:187], a[136:139], a[28:31], v[184:187]
  v_mfma_f32_16x16x32_bf16 v[184:187], a[128:131], a[12:15], v[184:187]
  s_waitcnt lgkmcnt(2)
  buffer_load_dwordx4 v82, s[20:23], s63 offen offset:2048  lds
  v_mfma_f32_16x16x32_bf16 v[160:163], a[160:163], a[64:67], v[160:163]
  v_mfma_f32_16x16x32_bf16 v[160:163], a[168:171], a[80:83], v[160:163]
  v_mfma_f32_16x16x32_bf16 v[160:163], a[176:179], a[96:99], v[160:163]
  v_lshrrev_b32 v1, 3, v23
  v_mfma_f32_16x16x32_bf16 v[160:163], a[184:187], a[112:115], v[160:163]
  s_waitcnt lgkmcnt(0)
  v_and_b32 v2, 1, v24
  v_mfma_f32_16x16x32_bf16 v[164:167], a[188:191], a[112:115], v[164:167]
  buffer_load_dwordx4 v83, s[20:23], s63 offen offset:3072  lds
  v_cmp_eq_u32 vcc, v1, v2
  v_mfma_f32_16x16x32_bf16 v[164:167], a[180:183], a[96:99], v[164:167]
  v_and_b32 v1, 1, v23
  v_mfma_f32_16x16x32_bf16 v[164:167], a[172:175], a[80:83], v[164:167]
  v_lshlrev_b32_e64 v1, 4, v1
  v_mfma_f32_16x16x32_bf16 v[164:167], a[164:167], a[64:67], v[164:167]
  s_xor_b32 s63, s55, 196608
  s_waitcnt vmcnt(24)
  v_mov_b32 v2, 0x3f80
  v_mfma_f32_16x16x32_bf16 v[172:175], a[164:167], a[68:71], v[172:175]
  s_add_u32 m0, s41, 81920
  s_barrier
  ds_read_b64_tr_b16 a[192:193], v124 offset:16384
  ds_read_b64_tr_b16 a[194:195], v124 offset:20480
  v_mfma_f32_16x16x32_bf16 v[172:175], a[172:175], a[84:87], v[172:175]
  buffer_load_dwordx4 v80, s[20:23], s63 offen offset:0  lds
  v_lshlrev_b32_e64 v1, v1, v2
  v_mfma_f32_16x16x32_bf16 v[172:175], a[180:183], a[100:103], v[172:175]
  ds_read_b64_tr_b16 a[196:197], v125 offset:16384
  v_cndmask_b32 v1, 0, v1, vcc
  v_mfma_f32_16x16x32_bf16 v[172:175], a[188:191], a[116:119], v[172:175]
  ds_read_b64_tr_b16 a[198:199], v125 offset:20480
  v_and_b32 v2, 4, v23
  v_mfma_f32_16x16x32_bf16 v[168:171], a[184:187], a[116:119], v[168:171]
  s_xor_b32 s62, s51, 524288
  ds_read_b64_tr_b16 a[200:201], v124 offset:24576
  v_cvt_pk_bf16_f32 v160, v160, v161
  v_mfma_f32_16x16x32_bf16 v[168:171], a[176:179], a[100:103], v[168:171]
  ds_read_b64_tr_b16 a[202:203], v124 offset:28672
  v_cvt_pk_bf16_f32 v161, v162, v163
  v_mfma_f32_16x16x32_bf16 v[168:171], a[168:171], a[84:87], v[168:171]
  buffer_load_dwordx4 v81, s[20:23], s63 offen offset:1024  lds
  v_cvt_pk_bf16_f32 v162, v164, v165
  v_mfma_f32_16x16x32_bf16 v[168:171], a[160:163], a[68:71], v[168:171]
  ds_read_b64_tr_b16 a[204:205], v125 offset:24576
  v_cvt_pk_bf16_f32 v163, v166, v167
  v_mfma_f32_16x16x32_bf16 v[176:179], a[160:163], a[72:75], v[176:179]
  ds_read_b64_tr_b16 a[206:207], v125 offset:28672
  v_cmp_eq_u32 vcc, 0, v2
  v_mfma_f32_16x16x32_bf16 v[176:179], a[168:171], a[88:91], v[176:179]
  ds_read_b64_tr_b16 a[208:209], v116 offset:0
  ds_read_b64_tr_b16 a[210:211], v116 offset:4096
  v_mfma_f32_16x16x32_bf16 v[176:179], a[176:179], a[104:107], v[176:179]
  ds_read_b64_tr_b16 a[212:213], v117 offset:0
  v_bfe_u32 v2, v23, 1, 1
  v_mfma_f32_16x16x32_bf16 v[176:179], a[184:187], a[120:123], v[176:179]
  buffer_load_dwordx4 v82, s[20:23], s63 offen offset:2048  lds
  v_mul_u32_u24 v2, 0xaaaa, v2
  v_mfma_f32_16x16x32_bf16 v[180:183], a[188:191], a[120:123], v[180:183]
  ds_read_b64_tr_b16 a[214:215], v117 offset:4096
  v_cndmask_b32 v8, 0, v1, vcc
  v_mfma_f32_16x16x32_bf16 v[180:183], a[180:183], a[104:107], v[180:183]
  ds_read_b64_tr_b16 a[216:217], v116 offset:8192
  v_sub_u32_e64 v10, v1, v8
  v_mfma_f32_16x16x32_bf16 v[180:183], a[172:175], a[88:91], v[180:183]
  ds_read_b64_tr_b16 a[218:219], v116 offset:12288
  v_add_u32 v20, 0x4444, v2
  v_mfma_f32_16x16x32_bf16 v[180:183], a[164:167], a[72:75], v[180:183]
  ds_read_b64_tr_b16 a[220:221], v117 offset:8192
  v_mov_b32_e64 v13, v8
  v_mfma_f32_16x16x32_bf16 v[188:191], a[164:167], a[76:79], v[188:191]
  buffer_load_dwordx4 v83, s[20:23], s63 offen offset:3072  lds
  v_mov_b32_e64 v15, v10
  v_mfma_f32_16x16x32_bf16 v[188:191], a[172:175], a[92:95], v[188:191]
  ds_read_b64_tr_b16 a[222:223], v117 offset:12288
  v_mov_b32_e64 v9, 0
  v_mfma_f32_16x16x32_bf16 v[188:191], a[180:183], a[108:111], v[188:191]
  buffer_store_dwordx4 v[160:163], v22, s[24:27], s62 offen sc1
  v_mov_b32_e64 v11, 0
  v_mfma_f32_16x16x32_bf16 v[188:191], a[188:191], a[124:127], v[188:191]
  s_xor_b32 s62, s51, 659456
  v_cvt_pk_bf16_f32 v168, v168, v169
  v_cvt_pk_bf16_f32 v169, v170, v171
  v_mfma_f32_16x16x32_bf16 v[184:187], a[184:187], a[124:127], v[184:187]
  v_cvt_pk_bf16_f32 v170, v172, v173
  v_cvt_pk_bf16_f32 v171, v174, v175
  v_mfma_f32_16x16x32_bf16 v[184:187], a[176:179], a[108:111], v[184:187]
  v_mov_b32_e64 v12, 0
  v_mfma_f32_16x16x32_bf16 v[184:187], a[168:171], a[92:95], v[184:187]
  buffer_store_dwordx4 v[168:171], v22, s[24:27], s62 offen sc1
  v_mov_b32_e64 v14, 0
  v_mfma_f32_16x16x32_bf16 v[184:187], a[160:163], a[76:79], v[184:187]
  s_waitcnt lgkmcnt(2)
  s_xor_b32 s62, s51, 802816
  v_cvt_pk_bf16_f32 v176, v176, v177
  v_cvt_pk_bf16_f32 v177, v178, v179
  v_mfma_f32_16x16x32_bf16 v[192:195], a[192:195], a[0:3], 0
  v_cvt_pk_bf16_f32 v178, v180, v181
  v_cvt_pk_bf16_f32 v179, v182, v183
  v_mfma_f32_16x16x32_bf16 v[192:195], a[200:203], a[16:19], v[192:195]
  v_mov_b32 v4, 0
  v_mfma_f32_16x16x32_bf16 v[192:195], a[208:211], a[32:35], v[192:195]
  buffer_store_dwordx4 v[176:179], v22, s[24:27], s62 offen sc1
  v_mov_b32_e64 v5, 0
  v_mfma_f32_16x16x32_bf16 v[192:195], a[216:219], a[48:51], v[192:195]
  s_waitcnt lgkmcnt(0)
  v_mov_b32 v6, 0
  v_mfma_f32_16x16x32_bf16 v[196:199], a[220:223], a[48:51], 0
  s_xor_b32 s62, s51, 937984
  v_cvt_pk_bf16_f32 v184, v184, v185
  v_cvt_pk_bf16_f32 v185, v186, v187
  v_mfma_f32_16x16x32_bf16 v[196:199], a[212:215], a[32:35], v[196:199]
  v_cvt_pk_bf16_f32 v186, v188, v189
  v_cvt_pk_bf16_f32 v187, v190, v191
  v_mfma_f32_16x16x32_bf16 v[196:199], a[204:207], a[16:19], v[196:199]
  v_mov_b32_e64 v7, 0
  v_mfma_f32_16x16x32_bf16 v[196:199], a[196:199], a[0:3], v[196:199]
  s_waitcnt vmcnt(22)
  buffer_store_dwordx4 v[184:187], v22, s[24:27], s62 offen sc1
  v_mov_b32 v16, 0
  v_mfma_f32_16x16x32_bf16 v[204:207], a[196:199], a[4:7], 0
  s_barrier
  ds_read_b64_tr_b16 a[224:225], v118 offset:32768
  v_mov_b32 v17, 0
  v_mfma_f32_16x16x32_bf16 v[204:207], a[204:207], a[20:23], v[204:207]
  ds_read_b64_tr_b16 a[226:227], v118 offset:36864
  v_mov_b32_e64 v18, 0
  v_mfma_f32_16x16x32_bf16 v[204:207], a[212:215], a[36:39], v[204:207]
  ds_read_b64_tr_b16 a[228:229], v119 offset:32768
  v_mov_b32_e64 v19, 0
  v_mfma_f32_16x16x32_bf16 v[204:207], a[220:223], a[52:55], v[204:207]
  ds_read_b64_tr_b16 a[230:231], v119 offset:36864
  v_mfma_f32_16x16x32_bf16 v[200:203], a[216:219], a[52:55], 0
  ds_read_b64_tr_b16 a[232:233], v118 offset:40960
  v_mfma_f32_16x16x32_bf16 v[200:203], a[208:211], a[36:39], v[200:203]
  ds_read_b64_tr_b16 a[234:235], v118 offset:45056
  v_mfma_f32_16x16x32_bf16 v[200:203], a[200:203], a[20:23], v[200:203]
  ds_read_b64_tr_b16 a[236:237], v119 offset:40960
  v_mfma_f32_16x16x32_bf16 v[200:203], a[192:195], a[4:7], v[200:203]
  ds_read_b64_tr_b16 a[238:239], v119 offset:45056
  v_mfma_f32_16x16x32_bf16 v[208:211], a[192:195], a[8:11], 0
  v_mfma_f32_16x16x32_bf16 v[208:211], a[200:203], a[24:27], v[208:211]
  ds_read_b64_tr_b16 a[240:241], v116 offset:16384
  v_mfma_f32_16x16x32_bf16 v[208:211], a[208:211], a[40:43], v[208:211]
  ds_read_b64_tr_b16 a[242:243], v116 offset:20480
  v_mfma_f32_16x16x32_bf16 v[208:211], a[216:219], a[56:59], v[208:211]
  ds_read_b64_tr_b16 a[244:245], v117 offset:16384
  v_mfma_f32_16x16x32_bf16 v[212:215], a[220:223], a[56:59], 0
  ds_read_b64_tr_b16 a[246:247], v117 offset:20480
  v_mfma_f32_16x16x32_bf16 v[212:215], a[212:215], a[40:43], v[212:215]
  ds_read_b64_tr_b16 a[248:249], v116 offset:24576
  v_mfma_f32_16x16x32_bf16 v[212:215], a[204:207], a[24:27], v[212:215]
  ds_read_b64_tr_b16 a[250:251], v116 offset:28672
  v_mfma_f32_16x16x32_bf16 v[212:215], a[196:199], a[8:11], v[212:215]
  ds_read_b64_tr_b16 a[252:253], v117 offset:24576
  v_mfma_f32_16x16x32_bf16 v[220:223], a[196:199], a[12:15], 0
  ds_read_b64_tr_b16 a[254:255], v117 offset:28672
  v_mfma_f32_16x16x32_bf16 v[220:223], a[204:207], a[28:31], v[220:223]
  v_mfma_f32_16x16x32_bf16 v[220:223], a[212:215], a[44:47], v[220:223]
  v_mfma_f32_16x16x32_bf16 v[220:223], a[220:223], a[60:63], v[220:223]
  v_mfma_f32_16x16x32_bf16 v[216:219], a[216:219], a[60:63], 0
  v_mfma_f32_16x16x32_bf16 v[216:219], a[208:211], a[44:47], v[216:219]
  v_mfma_f32_16x16x32_bf16 v[216:219], a[200:203], a[28:31], v[216:219]
  v_mfma_f32_16x16x32_bf16 v[216:219], a[192:195], a[12:15], v[216:219]
  s_waitcnt lgkmcnt(2)
  v_mfma_f32_16x16x32_bf16 v[192:195], a[224:227], a[64:67], v[192:195]
  v_mfma_f32_16x16x32_bf16 v[192:195], a[232:235], a[80:83], v[192:195]
  v_mfma_f32_16x16x32_bf16 v[192:195], a[240:243], a[96:99], v[192:195]
  v_mfma_f32_16x16x32_bf16 v[192:195], a[248:251], a[112:115], v[192:195]
  s_waitcnt lgkmcnt(0)
  v_mfma_f32_16x16x32_bf16 v[196:199], a[252:255], a[112:115], v[196:199]
  v_mfma_f32_16x16x32_bf16 v[196:199], a[244:247], a[96:99], v[196:199]
  v_mfma_f32_16x16x32_bf16 v[196:199], a[236:239], a[80:83], v[196:199]
  v_mfma_f32_16x16x32_bf16 v[196:199], a[228:231], a[64:67], v[196:199]
  s_waitcnt vmcnt(13)
  v_mfma_f32_16x16x32_bf16 v[204:207], a[228:231], a[68:71], v[204:207]
  s_barrier
  ds_read_b64_tr_b16 a[128:129], v118 offset:49152
  v_mfma_f32_16x16x32_bf16 v[204:207], a[236:239], a[84:87], v[204:207]
  ds_read_b64_tr_b16 a[130:131], v118 offset:53248
  v_mfma_f32_16x16x32_bf16 v[204:207], a[244:247], a[100:103], v[204:207]
  ds_read_b64_tr_b16 a[132:133], v119 offset:49152
  v_mfma_f32_16x16x32_bf16 v[204:207], a[252:255], a[116:119], v[204:207]
  ds_read_b64_tr_b16 a[134:135], v119 offset:53248
  v_mfma_f32_16x16x32_bf16 v[200:203], a[248:251], a[116:119], v[200:203]
  s_xor_b32 s62, s51, 1048576
  ds_read_b64_tr_b16 a[136:137], v118 offset:57344
  v_cvt_pk_bf16_f32 v192, v192, v193
  v_mfma_f32_16x16x32_bf16 v[200:203], a[240:243], a[100:103], v[200:203]
  ds_read_b64_tr_b16 a[138:139], v118 offset:61440
  v_cvt_pk_bf16_f32 v193, v194, v195
  v_mfma_f32_16x16x32_bf16 v[200:203], a[232:235], a[84:87], v[200:203]
  ds_read_b64_tr_b16 a[140:141], v119 offset:57344
  v_cvt_pk_bf16_f32 v194, v196, v197
  v_mfma_f32_16x16x32_bf16 v[200:203], a[224:227], a[68:71], v[200:203]
  ds_read_b64_tr_b16 a[142:143], v119 offset:61440
  v_cvt_pk_bf16_f32 v195, v198, v199
  v_mfma_f32_16x16x32_bf16 v[208:211], a[224:227], a[72:75], v[208:211]
  v_mfma_f32_16x16x32_bf16 v[208:211], a[232:235], a[88:91], v[208:211]
  ds_read_b64_tr_b16 a[144:145], v118 offset:0
  v_mfma_f32_16x16x32_bf16 v[208:211], a[240:243], a[104:107], v[208:211]
  ds_read_b64_tr_b16 a[146:147], v118 offset:4096
  v_mfma_f32_16x16x32_bf16 v[208:211], a[248:251], a[120:123], v[208:211]
  ds_read_b64_tr_b16 a[148:149], v119 offset:0
  v_mfma_f32_16x16x32_bf16 v[212:215], a[252:255], a[120:123], v[212:215]
  ds_read_b64_tr_b16 a[150:151], v119 offset:4096
  v_mfma_f32_16x16x32_bf16 v[212:215], a[244:247], a[104:107], v[212:215]
  ds_read_b64_tr_b16 a[152:153], v118 offset:8192
  v_mfma_f32_16x16x32_bf16 v[212:215], a[236:239], a[88:91], v[212:215]
  ds_read_b64_tr_b16 a[154:155], v118 offset:12288
  v_mfma_f32_16x16x32_bf16 v[212:215], a[228:231], a[72:75], v[212:215]
  ds_read_b64_tr_b16 a[156:157], v119 offset:8192
  v_mfma_f32_16x16x32_bf16 v[220:223], a[228:231], a[76:79], v[220:223]
  ds_read_b64_tr_b16 a[158:159], v119 offset:12288
  v_mfma_f32_16x16x32_bf16 v[220:223], a[236:239], a[92:95], v[220:223]
  buffer_store_dwordx4 v[192:195], v22, s[24:27], s62 offen sc1
  v_mfma_f32_16x16x32_bf16 v[220:223], a[244:247], a[108:111], v[220:223]
  s_xor_b32 s62, s51, 1183744
  v_cvt_pk_bf16_f32 v200, v200, v201
  v_cvt_pk_bf16_f32 v201, v202, v203
  v_mfma_f32_16x16x32_bf16 v[220:223], a[252:255], a[124:127], v[220:223]
  v_cvt_pk_bf16_f32 v202, v204, v205
  v_cvt_pk_bf16_f32 v203, v206, v207
  v_mfma_f32_16x16x32_bf16 v[216:219], a[248:251], a[124:127], v[216:219]
  v_mfma_f32_16x16x32_bf16 v[216:219], a[240:243], a[108:111], v[216:219]
  buffer_store_dwordx4 v[200:203], v22, s[24:27], s62 offen sc1
  v_mfma_f32_16x16x32_bf16 v[216:219], a[232:235], a[92:95], v[216:219]
  s_xor_b32 s62, s51, 1327104
  v_cvt_pk_bf16_f32 v208, v208, v209
  v_cvt_pk_bf16_f32 v209, v210, v211
  v_mfma_f32_16x16x32_bf16 v[216:219], a[224:227], a[76:79], v[216:219]
  s_waitcnt lgkmcnt(2)
  v_cvt_pk_bf16_f32 v210, v212, v213
  v_cvt_pk_bf16_f32 v211, v214, v215
  v_mfma_f32_16x16x32_bf16 v[224:227], a[128:131], a[0:3], 0
  v_mfma_f32_16x16x32_bf16 v[224:227], a[136:139], a[16:19], v[224:227]
  buffer_store_dwordx4 v[208:211], v22, s[24:27], s62 offen sc1
  v_mfma_f32_16x16x32_bf16 v[224:227], a[144:147], a[32:35], v[224:227]
  v_mfma_f32_16x16x32_bf16 v[224:227], a[152:155], a[48:51], v[224:227]
  s_waitcnt lgkmcnt(0)
  v_mfma_f32_16x16x32_bf16 v[228:231], a[156:159], a[48:51], 0
  s_xor_b32 s62, s51, 1462272
  v_cvt_pk_bf16_f32 v216, v216, v217
  v_cvt_pk_bf16_f32 v217, v218, v219
  v_mfma_f32_16x16x32_bf16 v[228:231], a[148:151], a[32:35], v[228:231]
  s_movk_i32 s53, 0x1000
  v_cvt_pk_bf16_f32 v218, v220, v221
  v_cvt_pk_bf16_f32 v219, v222, v223
  v_mfma_f32_16x16x32_bf16 v[228:231], a[140:143], a[16:19], v[228:231]
  s_movk_i32 s54, 0x4000
  v_mfma_f32_16x16x32_bf16 v[228:231], a[132:135], a[0:3], v[228:231]
  s_waitcnt vmcnt(7)
  buffer_store_dwordx4 v[216:219], v22, s[24:27], s62 offen sc1
  v_mfma_f32_16x16x32_bf16 v[236:239], a[132:135], a[4:7], 0
  s_barrier
  ds_read_b64_tr_b16 a[160:161], v116 offset:49152
  v_mfma_f32_16x16x32_bf16 v[236:239], a[140:143], a[20:23], v[236:239]
  s_movk_i32 s55, 0x5000
  ds_read_b64_tr_b16 a[162:163], v116 offset:53248
  v_mfma_f32_16x16x32_bf16 v[236:239], a[148:151], a[36:39], v[236:239]
  s_mov_b32 s56, 0
  ds_read_b64_tr_b16 a[164:165], v117 offset:49152
  v_mfma_f32_16x16x32_bf16 v[236:239], a[156:159], a[52:55], v[236:239]
  s_mov_b32 s95, 0
  ds_read_b64_tr_b16 a[166:167], v117 offset:53248
  v_mfma_f32_16x16x32_bf16 v[232:235], a[152:155], a[52:55], 0
  ds_read_b64_tr_b16 a[168:169], v116 offset:57344
  v_mfma_f32_16x16x32_bf16 v[232:235], a[144:147], a[36:39], v[232:235]
  ds_read_b64_tr_b16 a[170:171], v116 offset:61440
  v_mfma_f32_16x16x32_bf16 v[232:235], a[136:139], a[20:23], v[232:235]
  ds_read_b64_tr_b16 a[172:173], v117 offset:57344
  v_mfma_f32_16x16x32_bf16 v[232:235], a[128:131], a[4:7], v[232:235]
  ds_read_b64_tr_b16 a[174:175], v117 offset:61440
  v_mfma_f32_16x16x32_bf16 v[240:243], a[128:131], a[8:11], 0
  v_mfma_f32_16x16x32_bf16 v[240:243], a[136:139], a[24:27], v[240:243]
  ds_read_b64_tr_b16 a[176:177], v118 offset:16384
  v_mfma_f32_16x16x32_bf16 v[240:243], a[144:147], a[40:43], v[240:243]
  ds_read_b64_tr_b16 a[178:179], v118 offset:20480
  v_mfma_f32_16x16x32_bf16 v[240:243], a[152:155], a[56:59], v[240:243]
  ds_read_b64_tr_b16 a[180:181], v119 offset:16384
  v_mfma_f32_16x16x32_bf16 v[244:247], a[156:159], a[56:59], 0
  ds_read_b64_tr_b16 a[182:183], v119 offset:20480
  v_mfma_f32_16x16x32_bf16 v[244:247], a[148:151], a[40:43], v[244:247]
  ds_read_b64_tr_b16 a[184:185], v118 offset:24576
  v_mfma_f32_16x16x32_bf16 v[244:247], a[140:143], a[24:27], v[244:247]
  ds_read_b64_tr_b16 a[186:187], v118 offset:28672
  v_mfma_f32_16x16x32_bf16 v[244:247], a[132:135], a[8:11], v[244:247]
  ds_read_b64_tr_b16 a[188:189], v119 offset:24576
  v_mfma_f32_16x16x32_bf16 v[252:255], a[132:135], a[12:15], 0
  ds_read_b64_tr_b16 a[190:191], v119 offset:28672
  v_mfma_f32_16x16x32_bf16 v[252:255], a[140:143], a[28:31], v[252:255]
  v_mfma_f32_16x16x32_bf16 v[252:255], a[148:151], a[44:47], v[252:255]
  v_mfma_f32_16x16x32_bf16 v[252:255], a[156:159], a[60:63], v[252:255]
  v_mfma_f32_16x16x32_bf16 v[248:251], a[152:155], a[60:63], 0
  v_mfma_f32_16x16x32_bf16 v[248:251], a[144:147], a[44:47], v[248:251]
  v_mfma_f32_16x16x32_bf16 v[248:251], a[136:139], a[28:31], v[248:251]
  v_mfma_f32_16x16x32_bf16 v[248:251], a[128:131], a[12:15], v[248:251]
  s_waitcnt lgkmcnt(2)
  v_mfma_f32_16x16x32_bf16 v[224:227], a[160:163], a[64:67], v[224:227]
  v_mfma_f32_16x16x32_bf16 v[224:227], a[168:171], a[80:83], v[224:227]
  v_mfma_f32_16x16x32_bf16 v[224:227], a[176:179], a[96:99], v[224:227]
  v_mfma_f32_16x16x32_bf16 v[224:227], a[184:187], a[112:115], v[224:227]
  s_waitcnt lgkmcnt(0)
  v_mfma_f32_16x16x32_bf16 v[228:231], a[188:191], a[112:115], v[228:231]
  v_mfma_f32_16x16x32_bf16 v[228:231], a[180:183], a[96:99], v[228:231]
  v_mfma_f32_16x16x32_bf16 v[228:231], a[172:175], a[80:83], v[228:231]
  v_mfma_f32_16x16x32_bf16 v[228:231], a[164:167], a[64:67], v[228:231]
  v_mfma_f32_16x16x32_bf16 v[236:239], a[164:167], a[68:71], v[236:239]
  v_mfma_f32_16x16x32_bf16 v[236:239], a[172:175], a[84:87], v[236:239]
  v_mfma_f32_16x16x32_bf16 v[236:239], a[180:183], a[100:103], v[236:239]
  v_mfma_f32_16x16x32_bf16 v[236:239], a[188:191], a[116:119], v[236:239]
  v_mfma_f32_16x16x32_bf16 v[232:235], a[184:187], a[116:119], v[232:235]
  s_xor_b32 s62, s51, 1572864
  v_cvt_pk_bf16_f32 v224, v224, v225
  v_cvt_pk_bf16_f32 v225, v226, v227
  v_mfma_f32_16x16x32_bf16 v[232:235], a[176:179], a[100:103], v[232:235]
  v_cvt_pk_bf16_f32 v226, v228, v229
  v_cvt_pk_bf16_f32 v227, v230, v231
  v_mfma_f32_16x16x32_bf16 v[232:235], a[168:171], a[84:87], v[232:235]
  v_mfma_f32_16x16x32_bf16 v[232:235], a[160:163], a[68:71], v[232:235]
  buffer_store_dwordx4 v[224:227], v22, s[24:27], s62 offen sc1
  v_mfma_f32_16x16x32_bf16 v[240:243], a[160:163], a[72:75], v[240:243]
  v_mfma_f32_16x16x32_bf16 v[240:243], a[168:171], a[88:91], v[240:243]
  v_mfma_f32_16x16x32_bf16 v[240:243], a[176:179], a[104:107], v[240:243]
  v_mfma_f32_16x16x32_bf16 v[240:243], a[184:187], a[120:123], v[240:243]
  v_mfma_f32_16x16x32_bf16 v[244:247], a[188:191], a[120:123], v[244:247]
  s_xor_b32 s62, s51, 1708032
  s_nop 0
  v_cvt_pk_bf16_f32 v232, v232, v233
  v_cvt_pk_bf16_f32 v233, v234, v235
  v_mfma_f32_16x16x32_bf16 v[244:247], a[180:183], a[104:107], v[244:247]
  v_cvt_pk_bf16_f32 v234, v236, v237
  v_cvt_pk_bf16_f32 v235, v238, v239
  v_mfma_f32_16x16x32_bf16 v[244:247], a[172:175], a[88:91], v[244:247]
  v_mfma_f32_16x16x32_bf16 v[244:247], a[164:167], a[72:75], v[244:247]
  buffer_store_dwordx4 v[232:235], v22, s[24:27], s62 offen sc1
  v_mfma_f32_16x16x32_bf16 v[252:255], a[164:167], a[76:79], v[252:255]
  v_mfma_f32_16x16x32_bf16 v[252:255], a[172:175], a[92:95], v[252:255]
  v_mfma_f32_16x16x32_bf16 v[252:255], a[180:183], a[108:111], v[252:255]
  v_mfma_f32_16x16x32_bf16 v[252:255], a[188:191], a[124:127], v[252:255]
  v_mfma_f32_16x16x32_bf16 v[248:251], a[184:187], a[124:127], v[248:251]
  v_mfma_f32_16x16x32_bf16 v[248:251], a[176:179], a[108:111], v[248:251]
  v_mfma_f32_16x16x32_bf16 v[248:251], a[168:171], a[92:95], v[248:251]
  v_mfma_f32_16x16x32_bf16 v[248:251], a[160:163], a[76:79], v[248:251]
  s_xor_b32 s62, s51, 1851392
  v_cvt_pk_bf16_f32 v240, v240, v241
  v_cvt_pk_bf16_f32 v241, v242, v243
  v_cvt_pk_bf16_f32 v242, v244, v245
  v_cvt_pk_bf16_f32 v243, v246, v247
  buffer_store_dwordx4 v[240:243], v22, s[24:27], s62 offen sc1
  s_xor_b32 s62, s51, 1986560
  s_nop 0
  v_cvt_pk_bf16_f32 v248, v248, v249
  v_cvt_pk_bf16_f32 v249, v250, v251
  v_cvt_pk_bf16_f32 v250, v252, v253
  v_cvt_pk_bf16_f32 v251, v254, v255
  buffer_store_dwordx4 v[248:251], v22, s[24:27], s62 offen sc1
  s_load_dword s94, s[24:25], s92 glc
  s_waitcnt vmcnt(0)
  buffer_atomic_xor v29, v28, s[24:27], 0 offen offset:384 sc1
  s_waitcnt lgkmcnt(0)
  s_branch L_pF_e
L_pF:
  s_load_dword s94, s[24:25], s92 glc
  s_add_u32 s56, s56, 1
  s_cmp_ge_u32 s56, 262144
  s_waitcnt lgkmcnt(0)
  s_cbranch_scc1 L_pF_x
L_pF_e:
  s_xor_b32 s94, s94, s93
  s_andn2_b32 s45, s94, s95
  s_cbranch_scc0 L_pF
  s_or_b32 s95, s95, s45
  s_and_b32 s46, s45, 0xf
  s_cbranch_scc0 L_pq0
  s_bitcmp1_b32 s45, 0
  s_cbranch_scc0 L_pj0
  buffer_load_dwordx4 v[128:131], v30, s[24:27], 0 offen offset:0 sc1
L_pj0:
  s_bitcmp1_b32 s45, 1
  s_cbranch_scc0 L_pj1
  buffer_load_dwordx4 v[132:135], v30, s[24:27], 0 offen offset:1024 sc1
L_pj1:
  s_bitcmp1_b32 s45, 2
  s_cbranch_scc0 L_pj2
  buffer_load_dwordx4 v[136:139], v30, s[24:27], 0 offen offset:2048 sc1
L_pj2:
  s_bitcmp1_b32 s45, 3
  s_cbranch_scc0 L_pj3
  buffer_load_dwordx4 v[140:143], v30, s[24:27], 0 offen offset:3072 sc1
L_pj3:
L_pq0:
  s_and_b32 s46, s45, 0xf0
  s_cbranch_scc0 L_pq1
  s_bitcmp1_b32 s45, 4
  s_cbranch_scc0 L_pj4
  buffer_load_dwordx4 v[144:147], v30, s[24:27], s53 offen offset:0 sc1
L_pj4:
  s_bitcmp1_b32 s45, 5
  s_cbranch_scc0 L_pj5
  buffer_load_dwordx4 v[148:151], v30, s[24:27], s53 offen offset:1024 sc1
L_pj5:
  s_bitcmp1_b32 s45, 6
  s_cbranch_scc0 L_pj6
  buffer_load_dwordx4 v[152:155], v30, s[24:27], s53 offen offset:2048 sc1
L_pj6:
  s_bitcmp1_b32 s45, 7
  s_cbranch_scc0 L_pj7
  buffer_load_dwordx4 v[156:159], v30, s[24:27], s53 offen offset:3072 sc1
L_pj7:
L_pq1:
  s_and_b32 s46, s45, 0xf00
  s_cbranch_scc0 L_pq2
  s_bitcmp1_b32 s45, 8
  s_cbranch_scc0 L_pj8
  buffer_load_dwordx4 v[160:163], v30, s[24:27], s54 offen offset:0 sc1
L_pj8:
  s_bitcmp1_b32 s45, 9
  s_cbranch_scc0 L_pj9
  buffer_load_dwordx4 v[164:167], v30, s[24:27], s54 offen offset:1024 sc1
L_pj9:
  s_bitcmp1_b32 s45, 10
  s_cbranch_scc0 L_pj10
  buffer_load_dwordx4 v[168:171], v30, s[24:27], s54 offen offset:2048 sc1
L_pj10:
  s_bitcmp1_b32 s45, 11
  s_cbranch_scc0 L_pj11
  buffer_load_dwordx4 v[172:175], v30, s[24:27], s54 offen offset:3072 sc1
L_pj11:
L_pq2:
  s_and_b32 s46, s45, 0xf000
  s_cbranch_scc0 L_pq3
  s_bitcmp1_b32 s45, 12
  s_cbranch_scc0 L_pj12
  buffer_load_dwordx4 v[176:179], v30, s[24:27], s55 offen offset:0 sc1
L_pj12:
  s_bitcmp1_b32 s45, 13
  s_cbranch_scc0 L_pj13
  buffer_load_dwordx4 v[180:183], v30, s[24:27], s55 offen offset:1024 sc1
L_pj13:
  s_bitcmp1_b32 s45, 14
  s_cbranch_scc0 L_pj14
  buffer_load_dwordx4 v[184:187], v30, s[24:27], s55 offen offset:2048 sc1
L_pj14:
  s_bitcmp1_b32 s45, 15
  s_cbranch_scc0 L_pj15
  buffer_load_dwordx4 v[188:191], v30, s[24:27], s55 offen offset:3072 sc1
L_pj15:
L_pq3:
  s_cmp_eq_u32 s95, 0xffff
  s_cbranch_scc0 L_pF
L_pF_x:
  s_waitcnt vmcnt(0)
  v_smfmac_f32_16x16x64_bf16 v[16:19], v[8:11], v[128:135], v20
  v_smfmac_f32_16x16x64_bf16 v[4:7], v[12:15], v[128:135], v20
  v_smfmac_f32_16x16x64_bf16 v[16:19], v[8:11], v[136:143], v20
  v_smfmac_f32_16x16x64_bf16 v[4:7], v[12:15], v[136:143], v20
  v_smfmac_f32_16x16x64_bf16 v[16:19], v[8:11], v[144:151], v20
  v_smfmac_f32_16x16x64_bf16 v[4:7], v[12:15], v[144:151], v20
  v_smfmac_f32_16x16x64_bf16 v[16:19], v[8:11], v[152:159], v20
  v_smfmac_f32_16x16x64_bf16 v[4:7], v[12:15], v[152:159], v20
  v_smfmac_f32_16x16x64_bf16 v[16:19], v[8:11], v[160:167], v20
  v_smfmac_f32_16x16x64_bf16 v[4:7], v[12:15], v[160:167], v20
  v_smfmac_f32_16x16x64_bf16 v[16:19], v[8:11], v[168:175], v20
  v_smfmac_f32_16x16x64_bf16 v[4:7], v[12:15], v[168:175], v20
  v_smfmac_f32_16x16x64_bf16 v[16:19], v[8:11], v[176:183], v20
  v_smfmac_f32_16x16x64_bf16 v[4:7], v[12:15], v[176:183], v20
  v_smfmac_f32_16x16x64_bf16 v[16:19], v[8:11], v[184:191], v20
  v_smfmac_f32_16x16x64_bf16 v[4:7], v[12:15], v[184:191], v20
  s_nop 6
  v_cvt_pk_bf16_f32 v16, v16, v17
  v_cvt_pk_bf16_f32 v17, v18, v19
  v_cvt_pk_bf16_f32 v18, v4, v5
  v_cvt_pk_bf16_f32 v19, v6, v7
  s_nop 0
  v_permlane32_swap_b32 v16, v18
  v_permlane32_swap_b32 v17, v19
  s_nop 0
  v_permlane16_swap_b32 v16, v18
  v_permlane16_swap_b32 v17, v19
  buffer_store_dwordx4 v[16:19], v79, s[28:31], 0 offen sc1
L_end:
  s_endpgm
L_last:
L_rG:
  s_mov_b32 s56, 0
L_rG_l:
  s_load_dword s65, s[32:33], s64 glc
  s_add_u32 s56, s56, 1
  s_waitcnt lgkmcnt(0)
  s_cmp_ge_u32 s56, 262144
  s_cbranch_scc1 L_rG_b
  s_and_b32 s47, s65, 0xfff0
  s_cbranch_scc0 L_rG_l
  s_branch L_rG_b
L_fail:
  s_cmp_eq_u32 s101, 0
  s_cbranch_scc0 L_fail_b
  s_mov_b32 s101, 1
  s_waitcnt vmcnt(0) lgkmcnt(0)
  s_barrier
  s_nop 7
  s_branch L_top
L_slow:
  s_xor_b32 s92, s92, s37
  s_xor_b32 s51, s51, s37
  v_xor_b32_e64 v28, s37, v28
  v_xor_b32 v30, s37, v30
  s_waitcnt vmcnt(0)
  ds_read_b128 a[0:3], v96 offset:0
  ds_read_b128 a[4:7], v96 offset:1024
  ds_read_b128 a[8:11], v96 offset:2048
  ds_read_b128 a[12:15], v96 offset:3072
  ds_read_b128 a[16:19], v96 offset:4096
  ds_read_b128 a[20:23], v96 offset:5120
  ds_read_b128 a[24:27], v96 offset:6144
  ds_read_b128 a[28:31], v96 offset:7168
  v_mov_b32 v128, 0
  v_mov_b32 v129, 0
  v_mov_b32 v130, 0
  v_mov_b32 v131, 0
  v_mov_b32 v132, 0
  v_mov_b32 v133, 0
  v_mov_b32 v134, 0
  v_mov_b32 v135, 0
  v_mov_b32 v136, 0
  v_mov_b32 v137, 0
  v_mov_b32 v138, 0
  v_mov_b32 v139, 0
  v_mov_b32 v140, 0
  v_mov_b32 v141, 0
  v_mov_b32 v142, 0
  v_mov_b32 v143, 0
  v_mov_b32 v144, 0
  v_mov_b32 v145, 0
  v_mov_b32 v146, 0
  v_mov_b32 v147, 0
  v_mov_b32 v148, 0
  v_mov_b32 v149, 0
  v_mov_b32 v150, 0
  v_mov_b32 v151, 0
  v_mov_b32 v152, 0
  v_mov_b32 v153, 0
  v_mov_b32 v154, 0
  v_mov_b32 v155, 0
  v_mov_b32 v156, 0
  v_mov_b32 v157, 0
  v_mov_b32 v158, 0
  v_mov_b32 v159, 0
  v_mov_b32 v160, 0
  v_mov_b32 v161, 0
  v_mov_b32 v162, 0
  v_mov_b32 v163, 0
  v_mov_b32 v164, 0
  v_mov_b32 v165, 0
  v_mov_b32 v166, 0
  v_mov_b32 v167, 0
  v_mov_b32 v168, 0
  v_mov_b32 v169, 0
  v_mov_b32 v170, 0
  v_mov_b32 v171, 0
  v_mov_b32 v172, 0
  v_mov_b32 v173, 0
  v_mov_b32 v174, 0
  v_mov_b32 v175, 0
  v_mov_b32 v176, 0
  v_mov_b32 v177, 0
  v_mov_b32 v178, 0
  v_mov_b32 v179, 0
  v_mov_b32 v180, 0
  v_mov_b32 v181, 0
  v_mov_b32 v182, 0
  v_mov_b32 v183, 0
  v_mov_b32 v184, 0
  v_mov_b32 v185, 0
  v_mov_b32 v186, 0
  v_mov_b32 v187, 0
  v_mov_b32 v188, 0
  v_mov_b32 v189, 0
  v_mov_b32 v190, 0
  v_mov_b32 v191, 0
  v_mov_b32 v56, 0xff7fffff
  v_mov_b32_e64 v58, 0
  v_mov_b32 v57, 0xff7fffff
  v_mov_b32_e64 v59, 0
  s_mov_b32 s43, 0
  s_mov_b32 s48, 0
L_sl:
  s_waitcnt lgkmcnt(0)
  s_bitcmp1_b32 s48, 0
  s_cbranch_scc1 L_sl2
  s_barrier
  s_add_u32 m0, s41, 0
  s_nop 0
  buffer_load_dwordx4 v16, s[8:11], s43 offen offset:0 lds
  buffer_load_dwordx4 v17, s[8:11], s43 offen offset:1024 lds
  buffer_load_dwordx4 v18, s[8:11], s43 offen offset:2048 lds
  buffer_load_dwordx4 v19, s[8:11], s43 offen offset:3072 lds
  s_add_u32 m0, s41, 65536
  s_nop 0
  buffer_load_dwordx4 v20, s[12:15], s43 offen offset:0 lds
  buffer_load_dwordx4 v21, s[12:15], s43 offen offset:1024 lds
  buffer_load_dwordx4 v20, s[12:15], s43 offen offset:2048 lds
  buffer_load_dwordx4 v21, s[12:15], s43 offen offset:3072 lds
  s_sub_u32 s43, s43, s57
  s_and_b32 s43, s43, s57
  s_waitcnt vmcnt(0)
  s_barrier
L_sl2:
  ds_read_b128 a[64:67], v4 offset:0
  ds_read_b128 a[68:71], v5 offset:0
  ds_read_b128 a[72:75], v6 offset:0
  ds_read_b128 a[76:79], v7 offset:0
  ds_read_b128 a[80:83], v4 offset:4096
  ds_read_b128 a[84:87], v5 offset:4096
  ds_read_b128 a[88:91], v6 offset:4096
  ds_read_b128 a[92:95], v7 offset:4096
  ds_read_b64_tr_b16 a[128:129], v8 offset:0
  ds_read_b64_tr_b16 a[130:131], v8 offset:4096
  ds_read_b64_tr_b16 a[132:133], v9 offset:0
  ds_read_b64_tr_b16 a[134:135], v9 offset:4096
  ds_read_b64_tr_b16 a[136:137], v10 offset:0
  ds_read_b64_tr_b16 a[138:139], v10 offset:4096
  ds_read_b64_tr_b16 a[140:141], v11 offset:0
  ds_read_b64_tr_b16 a[142:143], v11 offset:4096
  ds_read_b64_tr_b16 a[144:145], v12 offset:0
  ds_read_b64_tr_b16 a[146:147], v12 offset:4096
  ds_read_b64_tr_b16 a[148:149], v13 offset:0
  ds_read_b64_tr_b16 a[150:151], v13 offset:4096
  ds_read_b64_tr_b16 a[152:153], v14 offset:0
  ds_read_b64_tr_b16 a[154:155], v14 offset:4096
  ds_read_b64_tr_b16 a[156:157], v15 offset:0
  ds_read_b64_tr_b16 a[158:159], v15 offset:4096
  v_xor_b32 v4, 0x2000, v4
  v_xor_b32 v5, 0x2000, v5
  v_xor_b32 v6, 0x2000, v6
  v_xor_b32 v7, 0x2000, v7
  v_xor_b32 v8, 0x2000, v8
  v_xor_b32 v9, 0x2000, v9
  v_xor_b32 v10, 0x2000, v10
  v_xor_b32 v11, 0x2000, v11
  v_xor_b32 v12, 0x2000, v12
  v_xor_b32 v13, 0x2000, v13
  v_xor_b32 v14, 0x2000, v14
  v_xor_b32 v15, 0x2000, v15
  s_waitcnt lgkmcnt(15)
  v_mfma_f32_16x16x32_bf16 v[32:35], a[64:67], a[0:3], 0
  v_mfma_f32_16x16x32_bf16 v[32:35], a[68:71], a[4:7], v[32:35]
  v_mfma_f32_16x16x32_bf16 v[32:35], a[72:75], a[8:11], v[32:35]
  v_mfma_f32_16x16x32_bf16 v[32:35], a[76:79], a[12:15], v[32:35]
  v_mfma_f32_16x16x32_bf16 v[36:39], a[80:83], a[0:3], 0
  v_mfma_f32_16x16x32_bf16 v[36:39], a[84:87], a[4:7], v[36:39]
  v_mfma_f32_16x16x32_bf16 v[36:39], a[88:91], a[8:11], v[36:39]
  v_mfma_f32_16x16x32_bf16 v[36:39], a[92:95], a[12:15], v[36:39]
  s_waitcnt lgkmcnt(14)
  s_nop 2
  v_max3_f32 v62, v32, v33, v56
  v_max3_f32 v62, v34, v35, v62
  s_nop 1
  v_max3_f32 v62, v36, v37, v62
  v_max3_f32 v62, v38, v39, v62
  v_mov_b32 v63, v62
  s_nop 1
  v_permlane32_swap_b32 v62, v63
  v_max_f32 v62, v62, v63
  v_mov_b32 v63, v62
  s_nop 1
  v_permlane16_swap_b32 v62, v63
  v_max_f32 v62, v62, v63
  v_sub_f32 v60, v56, v62
  v_exp_f32 v60, v60
  v_mov_b32 v56, v62
  v_mul_f32 v58, v60, v58
  v_sub_f32 v32, v32, v62
  v_sub_f32 v33, v33, v62
  v_sub_f32 v34, v34, v62
  v_sub_f32 v35, v35, v62
  v_sub_f32 v36, v36, v62
  v_sub_f32 v37, v37, v62
  v_sub_f32 v38, v38, v62
  v_sub_f32 v39, v39, v62
  v_exp_f32 v32, v32
  v_exp_f32 v33, v33
  v_exp_f32 v34, v34
  v_exp_f32 v35, v35
  v_exp_f32 v36, v36
  v_exp_f32 v37, v37
  v_exp_f32 v38, v38
  v_exp_f32 v39, v39
  v_add_f32 v58, v58, v32
  v_add_f32 v58, v58, v33
  v_add_f32 v58, v58, v34
  v_add_f32 v58, v58, v35
  v_add_f32 v58, v58, v36
  v_add_f32 v58, v58, v37
  v_add_f32 v58, v58, v38
  v_add_f32_e64 v58, v58, v39
  v_cvt_pk_bf16_f32 v48, v32, v33
  v_cvt_pk_bf16_f32 v49, v34, v35
  v_cvt_pk_bf16_f32 v50, v36, v37
  v_cvt_pk_bf16_f32 v51, v38, v39
  v_mul_f32 v128, v60, v128
  v_mul_f32 v129, v60, v129
  v_mul_f32 v130, v60, v130
  v_mul_f32 v131, v60, v131
  v_mul_f32 v132, v60, v132
  v_mul_f32 v133, v60, v133
  v_mul_f32 v134, v60, v134
  v_mul_f32 v135, v60, v135
  v_mul_f32 v136, v60, v136
  v_mul_f32 v137, v60, v137
  v_mul_f32 v138, v60, v138
  v_mul_f32 v139, v60, v139
  v_mul_f32 v140, v60, v140
  v_mul_f32 v141, v60, v141
  v_mul_f32 v142, v60, v142
  v_mul_f32 v143, v60, v143
  v_mul_f32 v144, v60, v144
  v_mul_f32 v145, v60, v145
  v_mul_f32 v146, v60, v146
  v_mul_f32 v147, v60, v147
  v_mul_f32 v148, v60, v148
  v_mul_f32 v149, v60, v149
  v_mul_f32 v150, v60, v150
  v_mul_f32 v151, v60, v151
  v_mul_f32 v152, v60, v152
  v_mul_f32 v153, v60, v153
  v_mul_f32 v154, v60, v154
  v_mul_f32 v155, v60, v155
  v_mul_f32 v156, v60, v156
  v_mul_f32 v157, v60, v157
  v_mul_f32 v158, v60, v158
  v_mul_f32 v159, v60, v159
  v_mfma_f32_16x16x32_bf16 v[128:131], a[128:131], v[48:51], v[128:131]
  s_waitcnt lgkmcnt(0)
  v_mfma_f32_16x16x32_bf16 v[132:135], a[132:135], v[48:51], v[132:135]
  v_mfma_f32_16x16x32_bf16 v[136:139], a[136:139], v[48:51], v[136:139]
  v_mfma_f32_16x16x32_bf16 v[140:143], a[140:143], v[48:51], v[140:143]
  v_mfma_f32_16x16x32_bf16 v[144:147], a[144:147], v[48:51], v[144:147]
  v_mfma_f32_16x16x32_bf16 v[148:151], a[148:151], v[48:51], v[148:151]
  v_mfma_f32_16x16x32_bf16 v[152:155], a[152:155], v[48:51], v[152:155]
  v_mfma_f32_16x16x32_bf16 v[156:159], a[156:159], v[48:51], v[156:159]
  v_mfma_f32_16x16x32_bf16 v[32:35], a[64:67], a[16:19], 0
  v_mfma_f32_16x16x32_bf16 v[32:35], a[68:71], a[20:23], v[32:35]
  v_mfma_f32_16x16x32_bf16 v[32:35], a[72:75], a[24:27], v[32:35]
  v_mfma_f32_16x16x32_bf16 v[32:35], a[76:79], a[28:31], v[32:35]
  v_mfma_f32_16x16x32_bf16 v[36:39], a[80:83], a[16:19], 0
  v_mfma_f32_16x16x32_bf16 v[36:39], a[84:87], a[20:23], v[36:39]
  v_mfma_f32_16x16x32_bf16 v[36:39], a[88:91], a[24:27], v[36:39]
  v_mfma_f32_16x16x32_bf16 v[36:39], a[92:95], a[28:31], v[36:39]
  s_nop 3
  v_max3_f32 v62, v32, v33, v57
  v_max3_f32 v62, v34, v35, v62
  s_nop 1
  v_max3_f32 v62, v36, v37, v62
  v_max3_f32 v62, v38, v39, v62
  v_mov_b32 v63, v62
  s_nop 1
  v_permlane32_swap_b32 v62, v63
  v_max_f32 v62, v62, v63
  v_mov_b32 v63, v62
  s_nop 1
  v_permlane16_swap_b32 v62, v63
  v_max_f32 v62, v62, v63
  v_sub_f32 v60, v57, v62
  v_exp_f32 v60, v60
  v_mov_b32 v57, v62
  v_mul_f32 v59, v60, v59
  v_sub_f32 v32, v32, v62
  v_sub_f32 v33, v33, v62
  v_sub_f32 v34, v34, v62
  v_sub_f32 v35, v35, v62
  v_sub_f32 v36, v36, v62
  v_sub_f32 v37, v37, v62
  v_sub_f32 v38, v38, v62
  v_sub_f32 v39, v39, v62
  v_exp_f32 v32, v32
  v_exp_f32 v33, v33
  v_exp_f32 v34, v34
  v_exp_f32 v35, v35
  v_exp_f32 v36, v36
  v_exp_f32 v37, v37
  v_exp_f32 v38, v38
  v_exp_f32 v39, v39
  v_add_f32 v59, v59, v32
  v_add_f32 v59, v59, v33
  v_add_f32 v59, v59, v34
  v_add_f32 v59, v59, v35
  v_add_f32 v59, v59, v36
  v_add_f32 v59, v59, v37
  v_add_f32 v59, v59, v38
  v_add_f32_e64 v59, v59, v39
  v_cvt_pk_bf16_f32 v48, v32, v33
  v_cvt_pk_bf16_f32 v49, v34, v35
  v_cvt_pk_bf16_f32 v50, v36, v37
  v_cvt_pk_bf16_f32 v51, v38, v39
  v_mul_f32 v160, v60, v160
  v_mul_f32 v161, v60, v161
  v_mul_f32 v162, v60, v162
  v_mul_f32 v163, v60, v163
  v_mul_f32 v164, v60, v164
  v_mul_f32 v165, v60, v165
  v_mul_f32 v166, v60, v166
  v_mul_f32 v167, v60, v167
  v_mul_f32 v168, v60, v168
  v_mul_f32 v169, v60, v169
  v_mul_f32 v170, v60, v170
  v_mul_f32 v171, v60, v171
  v_mul_f32 v172, v60, v172
  v_mul_f32 v173, v60, v173
  v_mul_f32 v174, v60, v174
  v_mul_f32 v175, v60, v175
  v_mul_f32 v176, v60, v176
  v_mul_f32 v177, v60, v177
  v_mul_f32 v178, v60, v178
  v_mul_f32 v179, v60, v179
  v_mul_f32 v180, v60, v180
  v_mul_f32 v181, v60, v181
  v_mul_f32 v182, v60, v182
  v_mul_f32 v183, v60, v183
  v_mul_f32 v184, v60, v184
  v_mul_f32 v185, v60, v185
  v_mul_f32 v186, v60, v186
  v_mul_f32 v187, v60, v187
  v_mul_f32 v188, v60, v188
  v_mul_f32 v189, v60, v189
  v_mul_f32 v190, v60, v190
  v_mul_f32 v191, v60, v191
  v_mfma_f32_16x16x32_bf16 v[160:163], a[128:131], v[48:51], v[160:163]
  v_mfma_f32_16x16x32_bf16 v[164:167], a[132:135], v[48:51], v[164:167]
  v_mfma_f32_16x16x32_bf16 v[168:171], a[136:139], v[48:51], v[168:171]
  v_mfma_f32_16x16x32_bf16 v[172:175], a[140:143], v[48:51], v[172:175]
  v_mfma_f32_16x16x32_bf16 v[176:179], a[144:147], v[48:51], v[176:179]
  v_mfma_f32_16x16x32_bf16 v[180:183], a[148:151], v[48:51], v[180:183]
  v_mfma_f32_16x16x32_bf16 v[184:187], a[152:155], v[48:51], v[184:187]
  v_mfma_f32_16x16x32_bf16 v[188:191], a[156:159], v[48:51], v[188:191]
  s_add_u32 s48, s48, 1
  s_cmp_lt_u32 s48, 64
  s_nop 7
  s_cbranch_scc1 L_sl
  v_mov_b32 v63, v58
  s_nop 1
  v_permlane32_swap_b32 v58, v63
  v_add_f32 v58, v58, v63
  v_mov_b32 v63, v58
  s_nop 1
  v_permlane16_swap_b32 v58, v63
  v_add_f32 v58, v58, v63
  v_mov_b32 v63, v59
  s_nop 1
  v_permlane32_swap_b32 v59, v63
  v_add_f32 v59, v59, v63
  v_mov_b32 v63, v59
  s_nop 1
  v_permlane16_swap_b32 v59, v63
  v_add_f32 v59, v59, v63
  v_mov_b32 v104, 0
  v_mov_b32 v105, 0
  v_mov_b32 v106, 0
  v_mov_b32 v107, 0
  v_mov_b32 v108, 0
  v_mov_b32 v109, 0
  v_mov_b32 v110, 0
  v_mov_b32 v111, 0
  v_mov_b32 v112, 0
  v_mov_b32 v113, 0
  v_mov_b32 v90, 0
  v_mov_b32 v91, 0
  v_mov_b32 v92, 0
  v_mov_b32 v93, 0
  v_mov_b32 v104, v58
  v_mov_b32 v90, v59
  v_add_f32 v104, v104, v105
  v_add_f32 v106, v106, v107
  v_add_f32 v104, v104, v112
  v_add_f32 v1, v104, v106
  v_rcp_f32 v26, v1
  s_nop 0
  v_pk_mul_f32 v[128:129], v[128:129], v[26:27] op_sel:[0,0] op_sel_hi:[1,0]
  v_pk_mul_f32 v[130:131], v[130:131], v[26:27] op_sel:[0,0] op_sel_hi:[1,0]
  v_pk_mul_f32 v[132:133], v[132:133], v[26:27] op_sel:[0,0] op_sel_hi:[1,0]
  v_pk_mul_f32 v[134:135], v[134:135], v[26:27] op_sel:[0,0] op_sel_hi:[1,0]
  v_cvt_pk_bf16_f32 v128, v128, v129
  v_cvt_pk_bf16_f32 v129, v130, v131
  v_cvt_pk_bf16_f32 v130, v132, v133
  v_cvt_pk_bf16_f32 v131, v134, v135
  ds_write_b128 v100, v[128:131] offset:0
  v_pk_mul_f32 v[136:137], v[136:137], v[26:27] op_sel:[0,0] op_sel_hi:[1,0]
  v_pk_mul_f32 v[138:139], v[138:139], v[26:27] op_sel:[0,0] op_sel_hi:[1,0]
  v_pk_mul_f32 v[140:141], v[140:141], v[26:27] op_sel:[0,0] op_sel_hi:[1,0]
  v_pk_mul_f32 v[142:143], v[142:143], v[26:27] op_sel:[0,0] op_sel_hi:[1,0]
  v_cvt_pk_bf16_f32 v136, v136, v137
  v_cvt_pk_bf16_f32 v137, v138, v139
  v_cvt_pk_bf16_f32 v138, v140, v141
  v_cvt_pk_bf16_f32 v139, v142, v143
  ds_write_b128 v100, v[136:139] offset:4096
  v_pk_mul_f32 v[144:145], v[144:145], v[26:27] op_sel:[0,0] op_sel_hi:[1,0]
  v_pk_mul_f32 v[146:147], v[146:147], v[26:27] op_sel:[0,0] op_sel_hi:[1,0]
  v_pk_mul_f32 v[148:149], v[148:149], v[26:27] op_sel:[0,0] op_sel_hi:[1,0]
  v_pk_mul_f32 v[150:151], v[150:151], v[26:27] op_sel:[0,0] op_sel_hi:[1,0]
  v_cvt_pk_bf16_f32 v144, v144, v145
  v_cvt_pk_bf16_f32 v145, v146, v147
  v_cvt_pk_bf16_f32 v146, v148, v149
  v_cvt_pk_bf16_f32 v147, v150, v151
  ds_write_b128 v100, v[144:147] offset:8192
  v_pk_mul_f32 v[152:153], v[152:153], v[26:27] op_sel:[0,0] op_sel_hi:[1,0]
  v_pk_mul_f32 v[154:155], v[154:155], v[26:27] op_sel:[0,0] op_sel_hi:[1,0]
  v_pk_mul_f32 v[156:157], v[156:157], v[26:27] op_sel:[0,0] op_sel_hi:[1,0]
  v_pk_mul_f32 v[158:159], v[158:159], v[26:27] op_sel:[0,0] op_sel_hi:[1,0]
  v_cvt_pk_bf16_f32 v152, v152, v153
  v_cvt_pk_bf16_f32 v153, v154, v155
  v_cvt_pk_bf16_f32 v154, v156, v157
  v_cvt_pk_bf16_f32 v155, v158, v159
  ds_write_b128 v100, v[152:155] offset:12288
  s_barrier
  s_xor_b32 s63, s52, 0
  s_add_u32 m0, s41, 131072
  s_nop 0
  buffer_load_dwordx4 v80, s[20:23], s63 offen offset:0  lds
  buffer_load_dwordx4 v81, s[20:23], s63 offen offset:1024  lds
  buffer_load_dwordx4 v82, s[20:23], s63 offen offset:2048  lds
  buffer_load_dwordx4 v83, s[20:23], s63 offen offset:3072  lds
  s_xor_b32 s63, s52, 65536
  s_add_u32 m0, s41, 147456
  s_nop 0
  buffer_load_dwordx4 v80, s[20:23], s63 offen offset:0  lds
  buffer_load_dwordx4 v81, s[20:23], s63 offen offset:1024  lds
  buffer_load_dwordx4 v82, s[20:23], s63 offen offset:2048  lds
  buffer_load_dwordx4 v83, s[20:23], s63 offen offset:3072  lds
  s_xor_b32 s63, s52, 131072
  s_add_u32 m0, s41, 0
  s_nop 0
  buffer_load_dwordx4 v80, s[20:23], s63 offen offset:0  lds
  buffer_load_dwordx4 v81, s[20:23], s63 offen offset:1024  lds
  buffer_load_dwordx4 v82, s[20:23], s63 offen offset:2048  lds
  buffer_load_dwordx4 v83, s[20:23], s63 offen offset:3072  lds
  s_xor_b32 s63, s52, 196608
  s_add_u32 m0, s41, 98304
  s_nop 0
  buffer_load_dwordx4 v80, s[20:23], s63 offen offset:0  lds
  buffer_load_dwordx4 v81, s[20:23], s63 offen offset:1024  lds
  buffer_load_dwordx4 v82, s[20:23], s63 offen offset:2048  lds
  buffer_load_dwordx4 v83, s[20:23], s63 offen offset:3072  lds
  s_waitcnt vmcnt(0)
  s_barrier
  ds_read_b64_tr_b16 a[192:193], v124 offset:0
  ds_read_b64_tr_b16 a[194:195], v124 offset:4096
  ds_read_b64_tr_b16 a[196:197], v125 offset:0
  ds_read_b64_tr_b16 a[198:199], v125 offset:4096
  ds_read_b64_tr_b16 a[200:201], v124 offset:8192
  ds_read_b64_tr_b16 a[202:203], v124 offset:12288
  ds_read_b64_tr_b16 a[204:205], v125 offset:8192
  ds_read_b64_tr_b16 a[206:207], v125 offset:12288
  ds_read_b64_tr_b16 a[208:209], v124 offset:16384
  ds_read_b64_tr_b16 a[210:211], v124 offset:20480
  ds_read_b64_tr_b16 a[212:213], v125 offset:16384
  ds_read_b64_tr_b16 a[214:215], v125 offset:20480
  ds_read_b64_tr_b16 a[216:217], v124 offset:24576
  ds_read_b64_tr_b16 a[218:219], v124 offset:28672
  ds_read_b64_tr_b16 a[220:221], v125 offset:24576
  ds_read_b64_tr_b16 a[222:223], v125 offset:28672
  ds_read_b64_tr_b16 a[224:225], v116 offset:0
  ds_read_b64_tr_b16 a[226:227], v116 offset:4096
  ds_read_b64_tr_b16 a[228:229], v117 offset:0
  ds_read_b64_tr_b16 a[230:231], v117 offset:4096
  ds_read_b64_tr_b16 a[232:233], v116 offset:8192
  ds_read_b64_tr_b16 a[234:235], v116 offset:12288
  ds_read_b64_tr_b16 a[236:237], v117 offset:8192
  ds_read_b64_tr_b16 a[238:239], v117 offset:12288
  ds_read_b64_tr_b16 a[240:241], v118 offset:32768
  ds_read_b64_tr_b16 a[242:243], v118 offset:36864
  ds_read_b64_tr_b16 a[244:245], v119 offset:32768
  ds_read_b64_tr_b16 a[246:247], v119 offset:36864
  ds_read_b64_tr_b16 a[248:249], v118 offset:40960
  ds_read_b64_tr_b16 a[250:251], v118 offset:45056
  ds_read_b64_tr_b16 a[252:253], v119 offset:40960
  ds_read_b64_tr_b16 a[254:255], v119 offset:45056
  s_waitcnt lgkmcnt(0)
  s_barrier
  s_xor_b32 s63, s53, 0
  s_add_u32 m0, s41, 16384
  s_nop 0
  buffer_load_dwordx4 v80, s[20:23], s63 offen offset:0  lds
  buffer_load_dwordx4 v81, s[20:23], s63 offen offset:1024  lds
  buffer_load_dwordx4 v82, s[20:23], s63 offen offset:2048  lds
  buffer_load_dwordx4 v83, s[20:23], s63 offen offset:3072  lds
  s_xor_b32 s63, s53, 65536
  s_add_u32 m0, s41, 114688
  s_nop 0
  buffer_load_dwordx4 v80, s[20:23], s63 offen offset:0  lds
  buffer_load_dwordx4 v81, s[20:23], s63 offen offset:1024  lds
  buffer_load_dwordx4 v82, s[20:23], s63 offen offset:2048  lds
  buffer_load_dwordx4 v83, s[20:23], s63 offen offset:3072  lds
  s_xor_b32 s63, s53, 131072
  s_add_u32 m0, s41, 32768
  s_nop 0
  buffer_load_dwordx4 v80, s[20:23], s63 offen offset:0  lds
  buffer_load_dwordx4 v81, s[20:23], s63 offen offset:1024  lds
  buffer_load_dwordx4 v82, s[20:23], s63 offen offset:2048  lds
  buffer_load_dwordx4 v83, s[20:23], s63 offen offset:3072  lds
  s_xor_b32 s63, s53, 196608
  s_add_u32 m0, s41, 131072
  s_nop 0
  buffer_load_dwordx4 v80, s[20:23], s63 offen offset:0  lds
  buffer_load_dwordx4 v81, s[20:23], s63 offen offset:1024  lds
  buffer_load_dwordx4 v82, s[20:23], s63 offen offset:2048  lds
  buffer_load_dwordx4 v83, s[20:23], s63 offen offset:3072  lds
  s_xor_b32 s63, s54, 0
  s_add_u32 m0, s41, 147456
  s_nop 0
  buffer_load_dwordx4 v80, s[20:23], s63 offen offset:0  lds
  buffer_load_dwordx4 v81, s[20:23], s63 offen offset:1024  lds
  buffer_load_dwordx4 v82, s[20:23], s63 offen offset:2048  lds
  buffer_load_dwordx4 v83, s[20:23], s63 offen offset:3072  lds
  s_waitcnt vmcnt(0)
  s_nop 7
  s_branch L_norm
.section .rodata,"a"
.p2align 6
.amdhsa_kernel concat_heads__gqa_block_cached__gqa_block_cached__near_ridge_kernel
  .amdhsa_next_free_vgpr 512
  .amdhsa_next_free_sgpr 102
  .amdhsa_accum_offset 256
  .amdhsa_group_segment_fixed_size 0
  .amdhsa_kernarg_size 104
  .amdhsa_user_sgpr_count 2
  .amdhsa_user_sgpr_kernarg_segment_ptr 1
  .amdhsa_system_sgpr_workgroup_id_x 1
  .amdhsa_float_denorm_mode_32 3
.end_amdhsa_kernel
```
